```python
import torch

def _softmax(x, axis=-1):
    return torch.softmax(x, dim=axis)
def _gelu(x):
    return torch.nn.functional.gelu(x, approximate="tanh")
def _silu(x):
    return torch.nn.functional.silu(x)
def _sigmoid(x):
    return torch.sigmoid(x)
def _layernorm(x, axis=-1, eps=1e-5):
    m = x.mean(dim=axis, keepdim=True)
    v = x.var(dim=axis, keepdim=True, unbiased=False)
    return (x - m) / torch.sqrt(v + eps)
def _scatter_add(tgt, idx, src, axis=0):
    return tgt.clone().index_add_(axis, idx, src)
def _segment_sum(src, seg, n):
    out = torch.zeros((n,) + src.shape[1:], dtype=src.dtype)
    return out.index_add_(0, seg, src)
def _pad(x, pw):
    flat = tuple(v for pair in reversed(pw) for v in pair)
    return torch.nn.functional.pad(x, flat)

kernel_name = 'sequential_preLN__gqa_block_cached__swiglu_ffn__decode'

def setup_inputs():

    _w = (lambda a: (lambda t: t.to(torch.bfloat16) if t.is_floating_point() else t)(torch.as_tensor(a)))
    def _A_setup():
        B, Sq, D = 4, 1, 640
        Hq, Hkv, Sk, Dh = 32, 32, 4096, 192
        assert Hq % Hkv == 0, (Hq, Hkv)
        return {
            "x": _w((lambda *s: torch.randn(*s, dtype=torch.bfloat16) * 0.05)(B, Sq, D)),
            "k_cache": _w((lambda *s: torch.randn(*s, dtype=torch.bfloat16) * 3.2)(B, Hkv, Sk, Dh)),
            "v_cache": _w((lambda *s: torch.randn(*s, dtype=torch.bfloat16) * 0.4)(B, Hkv, Sk, Dh)),
            "wq": _w((lambda *s: torch.randn(*s, dtype=torch.bfloat16) * 3.2)(D, Hq * Dh) * (D ** -0.5)),
            "wo": _w((lambda *s: torch.randn(*s, dtype=torch.bfloat16) * 0.4)(Hq * Dh, D) * ((Hq * Dh) ** -0.5)),
        }
    _A_in = _A_setup()

    def _B_setup():
        B, S, D, F = 4, 1, 640, 1536
        return {
            "x": _w((lambda *s: torch.randn(*s, dtype=torch.bfloat16) * 0.05)(B, S, D)),
            "w_gate": _w((lambda *s: torch.randn(*s, dtype=torch.bfloat16) * 0.05)(D, F)),
            "w_up": _w((lambda *s: torch.randn(*s, dtype=torch.bfloat16) * 0.05)(D, F)),
            "w_down": _w((lambda *s: torch.randn(*s, dtype=torch.bfloat16) * 0.05)(F, D)),
        }
    _B_in = _B_setup()

    return {
        "A_x": _A_in["x"],
        "A_k_cache": _A_in["k_cache"],
        "A_v_cache": _A_in["v_cache"],
        "A_wq": _A_in["wq"],
        "A_wo": _A_in["wo"],
        "B_x": _B_in["x"],
        "B_w_gate": _B_in["w_gate"],
        "B_w_up": _B_in["w_up"],
        "B_w_down": _B_in["w_down"],
    }

def reference(A_x, A_k_cache, A_v_cache, A_wq, A_wo, B_x, B_w_gate, B_w_up, B_w_down):
    def _A_ref(x, k_cache, v_cache, wq, wo):
        B, Sq, D = x.shape
        Hq, Dh = 32, 192
        Hkv = k_cache.shape[1]
        rep = Hq // Hkv
        q = (lambda x, *d: x.permute(*d))((x @ wq).reshape(B, Sq, Hq, Dh), 0, 2, 1, 3)
        k = (lambda x, n, axis: torch.repeat_interleave(x, n, dim=axis))(k_cache, rep, axis=1)
        v = (lambda x, n, axis: torch.repeat_interleave(x, n, dim=axis))(v_cache, rep, axis=1)
        scores = torch.einsum("bhqd,bhkd->bhqk", q, k) * (Dh ** -0.5)
        p = _softmax(scores, axis=-1)
        o = torch.einsum("bhqk,bhkd->bhqd", p, v)
        return (lambda x, *d: x.permute(*d))(o, 0, 2, 1, 3).reshape(B, Sq, Hq * Dh) @ wo

    def _B_ref(x, w_gate, w_up, w_down):
        g = _silu(x @ w_gate)
        u = x @ w_up
        return (g * u) @ w_down

    x = A_x
    h = x + _A_ref(_layernorm(x, axis=-1), A_k_cache, A_v_cache, A_wq, A_wo)
    h2 = h + _B_ref(_layernorm(h, axis=-1), B_w_gate, B_w_up, B_w_down)
    return h2
```

```asm
; @launch grid=(256,1,1) block=(512,1,1) lds=161856
.amdgcn_target "amdgcn-amd-amdhsa--gfx950"
.text
.globl sequential_preLN__gqa_block_cached__swiglu_ffn__decode_kernel
.p2align 8
.type sequential_preLN__gqa_block_cached__swiglu_ffn__decode_kernel,@function
sequential_preLN__gqa_block_cached__swiglu_ffn__decode_kernel:
    s_cmp_ge_u32 s2, 256
    s_cbranch_scc1 L_end
    s_load_dwordx16 s[4:19], s[0:1], 0
    s_load_dwordx8 s[20:27], s[0:1], 64
    v_lshrrev_b32 v1, 6, v0
    v_and_b32 v0, 63, v0
    v_readfirstlane_b32 s3, v1
    s_lshr_b32 s72, s2, 3
    s_and_b32 s73, s2, 7
    s_and_b32 s74, s3, 3
    s_mul_i32 s82, s74, s73
    s_add_u32 s82, s82, s72
    s_and_b32 s82, s82, 31
    s_cmp_lt_u32 s3, 4
    s_cbranch_scc1 L_helper
    v_lshrrev_b32 v3, 3, v0
    v_mul_u32_u24 v3, 384, v3
    v_and_b32 v4, 7, v0
    v_lshl_add_u32 v1, v4, 4, v3
    s_lshl_b32 s77, s74, 5
    s_add_u32 s77, s77, s82
    s_mul_i32 s78, s77, 1572864
    s_mul_i32 s75, s73, 3072
    s_waitcnt lgkmcnt(0)
    s_add_u32 s32, s6, s78
    s_addc_u32 s33, s7, 0
    s_mov_b32 s34, 1572864
    s_mov_b32 s35, 0x20000
    s_add_u32 s36, s8, s78
    s_addc_u32 s37, s9, 0
    s_mov_b32 s38, 1572864
    s_mov_b32 s39, 0x20000
    buffer_load_dwordx4 v[64:67], v1, s[32:35], s75 offen offset:0 nt
    buffer_load_dwordx4 v[68:71], v1, s[32:35], s75 offen offset:128 nt
    buffer_load_dwordx4 v[72:75], v1, s[32:35], s75 offen offset:256 nt
    buffer_load_dwordx4 v[76:79], v1, s[36:39], s75 offen offset:0 nt
    buffer_load_dwordx4 v[80:83], v1, s[36:39], s75 offen offset:128 nt
    buffer_load_dwordx4 v[84:87], v1, s[36:39], s75 offen offset:256 nt
    s_add_u32 s75, s75, 24576
    buffer_load_dwordx4 v[88:91], v1, s[32:35], s75 offen offset:0 nt
    buffer_load_dwordx4 v[92:95], v1, s[32:35], s75 offen offset:128 nt
    buffer_load_dwordx4 v[96:99], v1, s[32:35], s75 offen offset:256 nt
    buffer_load_dwordx4 v[100:103], v1, s[36:39], s75 offen offset:0 nt
    buffer_load_dwordx4 v[104:107], v1, s[36:39], s75 offen offset:128 nt
    buffer_load_dwordx4 v[108:111], v1, s[36:39], s75 offen offset:256 nt
    s_add_u32 s75, s75, 24576
    buffer_load_dwordx4 v[112:115], v1, s[32:35], s75 offen offset:0 nt
    buffer_load_dwordx4 v[116:119], v1, s[32:35], s75 offen offset:128 nt
    buffer_load_dwordx4 v[120:123], v1, s[32:35], s75 offen offset:256 nt
    buffer_load_dwordx4 v[124:127], v1, s[36:39], s75 offen offset:0 nt
    buffer_load_dwordx4 v[128:131], v1, s[36:39], s75 offen offset:128 nt
    buffer_load_dwordx4 v[132:135], v1, s[36:39], s75 offen offset:256 nt
    s_add_u32 s75, s75, 24576
    v_mov_b32 v2, 0
    s_lshl_b32 s76, s77, 8
    s_add_u32 s76, s76, 6356992
    s_lshl_b32 s83, s77, 3
    s_add_u32 s83, s83, s73
    s_lshl_b32 s83, s83, 11
    s_add_u32 s83, s83, 2097152
    s_mul_i32 s77, s74, 24576
    s_add_u32 s77, s77, 63552
    s_mul_i32 s80, s74, 12288
    v_lshlrev_b32 v23, 4, v0
    v_add_u32 v22, s77, v23
    v_add_u32 v23, s80, v23
    s_mov_b32 s28, s26
    s_mov_b32 s29, s27
    s_mov_b32 s30, 16777216
    s_mov_b32 s31, 0x20000
    s_add_u32 s66, s26, s76
    s_addc_u32 s67, s27, 0
    s_barrier
    v_mov_b32 v11, 0xff7fffff
    v_mov_b32 v12, 0
    v_mov_b32 v36, 0
    v_mov_b32 v37, 0
    v_mov_b32 v38, 0
    v_mov_b32 v39, 0
    v_mov_b32 v40, 0
    v_mov_b32 v41, 0
    v_mov_b32 v42, 0
    v_mov_b32 v43, 0
    v_mov_b32 v44, 0
    v_mov_b32 v45, 0
    v_mov_b32 v46, 0
    v_mov_b32 v47, 0
    v_mov_b32 v48, 0
    v_mov_b32 v49, 0
    v_mov_b32 v50, 0
    v_mov_b32 v51, 0
    v_mov_b32 v52, 0
    v_mov_b32 v53, 0
    v_mov_b32 v54, 0
    v_mov_b32 v55, 0
    v_mov_b32 v56, 0
    v_mov_b32 v57, 0
    v_mov_b32 v58, 0
    v_mov_b32 v59, 0
    s_waitcnt vmcnt(12)
    buffer_load_dwordx4 v[136:139], v1, s[32:35], s75 offen offset:0 nt
    buffer_load_dwordx4 v[140:143], v1, s[32:35], s75 offen offset:128 nt
    buffer_load_dwordx4 v[144:147], v1, s[32:35], s75 offen offset:256 nt
    buffer_load_dwordx4 v[148:151], v1, s[36:39], s75 offen offset:0 nt
    buffer_load_dwordx4 v[152:155], v1, s[36:39], s75 offen offset:128 nt
    buffer_load_dwordx4 v[156:159], v1, s[36:39], s75 offen offset:256 nt
    s_add_u32 s75, s75, 24576
    s_waitcnt vmcnt(12)
    buffer_load_dwordx4 v[160:163], v1, s[32:35], s75 offen offset:0 nt
    buffer_load_dwordx4 v[164:167], v1, s[32:35], s75 offen offset:128 nt
    buffer_load_dwordx4 v[168:171], v1, s[32:35], s75 offen offset:256 nt
    buffer_load_dwordx4 v[172:175], v1, s[36:39], s75 offen offset:0 nt
    buffer_load_dwordx4 v[176:179], v1, s[36:39], s75 offen offset:128 nt
    buffer_load_dwordx4 v[180:183], v1, s[36:39], s75 offen offset:256 nt
    s_add_u32 s75, s75, 24576
    s_waitcnt vmcnt(12)
    buffer_load_dwordx4 v[184:187], v1, s[32:35], s75 offen offset:0 nt
    buffer_load_dwordx4 v[188:191], v1, s[32:35], s75 offen offset:128 nt
    buffer_load_dwordx4 v[192:195], v1, s[32:35], s75 offen offset:256 nt
    buffer_load_dwordx4 v[196:199], v1, s[36:39], s75 offen offset:0 nt
    buffer_load_dwordx4 v[200:203], v1, s[36:39], s75 offen offset:128 nt
    buffer_load_dwordx4 v[204:207], v1, s[36:39], s75 offen offset:256 nt
    s_add_u32 s75, s75, 24576
    s_waitcnt vmcnt(12)
    buffer_load_dwordx4 v[208:211], v1, s[32:35], s75 offen offset:0 nt
    buffer_load_dwordx4 v[212:215], v1, s[32:35], s75 offen offset:128 nt
    buffer_load_dwordx4 v[216:219], v1, s[32:35], s75 offen offset:256 nt
    buffer_load_dwordx4 v[220:223], v1, s[36:39], s75 offen offset:0 nt
    buffer_load_dwordx4 v[224:227], v1, s[36:39], s75 offen offset:128 nt
    buffer_load_dwordx4 v[228:231], v1, s[36:39], s75 offen offset:256 nt
    s_add_u32 s75, s75, 24576
    s_waitcnt vmcnt(12)
    buffer_load_dwordx4 v[232:235], v1, s[32:35], s75 offen offset:0 nt
    buffer_load_dwordx4 v[236:239], v1, s[32:35], s75 offen offset:128 nt
    buffer_load_dwordx4 v[240:243], v1, s[32:35], s75 offen offset:256 nt
    buffer_load_dwordx4 v[244:247], v1, s[36:39], s75 offen offset:0 nt
    buffer_load_dwordx4 v[248:251], v1, s[36:39], s75 offen offset:128 nt
    buffer_load_dwordx4 v[252:255], v1, s[36:39], s75 offen offset:256 nt
    s_add_u32 s75, s75, 24576
    s_waitcnt vmcnt(12)
    s_mov_b32 s81, 8000000
L_lw_1:
    ds_read_b32 v3, v2 offset:63492
    s_waitcnt lgkmcnt(0)
    v_readfirstlane_b32 s79, v3
    s_nop 0
    s_cmp_ge_u32 s79, 4
    s_cbranch_scc1 L_lwd_2
    s_sleep 1
    s_sub_u32 s81, s81, 1
    s_cmp_lg_u32 s81, 0
    s_cbranch_scc1 L_lw_1
L_lwd_2:
    s_add_u32 m0, s77, 0
    s_nop 0
    buffer_load_dwordx4 v1, s[32:35], s75 offen offset:0 nt lds
    s_add_u32 m0, s77, 896
    s_nop 0
    buffer_load_dwordx4 v1, s[32:35], s75 offen offset:128 nt lds
    s_add_u32 m0, s77, 1792
    s_nop 0
    buffer_load_dwordx4 v1, s[32:35], s75 offen offset:256 nt lds
    s_add_u32 m0, s77, 3072
    s_nop 0
    buffer_load_dwordx4 v1, s[36:39], s75 offen offset:0 nt lds
    s_add_u32 m0, s77, 3968
    s_nop 0
    buffer_load_dwordx4 v1, s[36:39], s75 offen offset:128 nt lds
    s_add_u32 m0, s77, 4864
    s_nop 0
    buffer_load_dwordx4 v1, s[36:39], s75 offen offset:256 nt lds
    s_add_u32 s75, s75, 24576
    s_waitcnt vmcnt(12)
    s_add_u32 m0, s77, 6144
    s_nop 0
    buffer_load_dwordx4 v1, s[32:35], s75 offen offset:0 nt lds
    s_add_u32 m0, s77, 7040
    s_nop 0
    buffer_load_dwordx4 v1, s[32:35], s75 offen offset:128 nt lds
    s_add_u32 m0, s77, 7936
    s_nop 0
    buffer_load_dwordx4 v1, s[32:35], s75 offen offset:256 nt lds
    s_add_u32 m0, s77, 9216
    s_nop 0
    buffer_load_dwordx4 v1, s[36:39], s75 offen offset:0 nt lds
    s_add_u32 m0, s77, 10112
    s_nop 0
    buffer_load_dwordx4 v1, s[36:39], s75 offen offset:128 nt lds
    s_add_u32 m0, s77, 11008
    s_nop 0
    buffer_load_dwordx4 v1, s[36:39], s75 offen offset:256 nt lds
    s_add_u32 s75, s75, 24576
    s_waitcnt vmcnt(12)
    s_add_u32 m0, s77, 12288
    s_nop 0
    buffer_load_dwordx4 v1, s[32:35], s75 offen offset:0 nt lds
    s_add_u32 m0, s77, 13184
    s_nop 0
    buffer_load_dwordx4 v1, s[32:35], s75 offen offset:128 nt lds
    s_add_u32 m0, s77, 14080
    s_nop 0
    buffer_load_dwordx4 v1, s[32:35], s75 offen offset:256 nt lds
    s_add_u32 m0, s77, 15360
    s_nop 0
    buffer_load_dwordx4 v1, s[36:39], s75 offen offset:0 nt lds
    s_add_u32 m0, s77, 16256
    s_nop 0
    buffer_load_dwordx4 v1, s[36:39], s75 offen offset:128 nt lds
    s_add_u32 m0, s77, 17152
    s_nop 0
    buffer_load_dwordx4 v1, s[36:39], s75 offen offset:256 nt lds
    s_add_u32 s75, s75, 24576
    s_waitcnt vmcnt(12)
    s_add_u32 m0, s77, 18432
    s_nop 0
    buffer_load_dwordx4 v1, s[32:35], s75 offen offset:0 nt lds
    s_add_u32 m0, s77, 19328
    s_nop 0
    buffer_load_dwordx4 v1, s[32:35], s75 offen offset:128 nt lds
    s_add_u32 m0, s77, 20224
    s_nop 0
    buffer_load_dwordx4 v1, s[32:35], s75 offen offset:256 nt lds
    s_add_u32 m0, s77, 21504
    s_nop 0
    buffer_load_dwordx4 v1, s[36:39], s75 offen offset:0 nt lds
    s_add_u32 m0, s77, 22400
    s_nop 0
    buffer_load_dwordx4 v1, s[36:39], s75 offen offset:128 nt lds
    s_add_u32 m0, s77, 23296
    s_nop 0
    buffer_load_dwordx4 v1, s[36:39], s75 offen offset:256 nt lds
    s_add_u32 s75, s75, 24576
    s_waitcnt vmcnt(12)
    s_add_u32 m0, s80, 0
    s_nop 0
    buffer_load_dwordx4 v1, s[32:35], s75 offen offset:0 nt lds
    s_add_u32 m0, s80, 896
    s_nop 0
    buffer_load_dwordx4 v1, s[32:35], s75 offen offset:128 nt lds
    s_add_u32 m0, s80, 1792
    s_nop 0
    buffer_load_dwordx4 v1, s[32:35], s75 offen offset:256 nt lds
    s_add_u32 m0, s80, 3072
    s_nop 0
    buffer_load_dwordx4 v1, s[36:39], s75 offen offset:0 nt lds
    s_add_u32 m0, s80, 3968
    s_nop 0
    buffer_load_dwordx4 v1, s[36:39], s75 offen offset:128 nt lds
    s_add_u32 m0, s80, 4864
    s_nop 0
    buffer_load_dwordx4 v1, s[36:39], s75 offen offset:256 nt lds
    s_add_u32 s75, s75, 24576
    s_waitcnt vmcnt(12)
    s_add_u32 m0, s80, 6144
    s_nop 0
    buffer_load_dwordx4 v1, s[32:35], s75 offen offset:0 nt lds
    s_add_u32 m0, s80, 7040
    s_nop 0
    buffer_load_dwordx4 v1, s[32:35], s75 offen offset:128 nt lds
    s_add_u32 m0, s80, 7936
    s_nop 0
    buffer_load_dwordx4 v1, s[32:35], s75 offen offset:256 nt lds
    s_add_u32 m0, s80, 9216
    s_nop 0
    buffer_load_dwordx4 v1, s[36:39], s75 offen offset:0 nt lds
    s_add_u32 m0, s80, 10112
    s_nop 0
    buffer_load_dwordx4 v1, s[36:39], s75 offen offset:128 nt lds
    s_add_u32 m0, s80, 11008
    s_nop 0
    buffer_load_dwordx4 v1, s[36:39], s75 offen offset:256 nt lds
    s_add_u32 s75, s75, 24576
    s_mov_b32 s81, 8000000
L_lw_3:
    ds_read_b32 v3, v2 offset:63496
    s_waitcnt lgkmcnt(0)
    v_readfirstlane_b32 s79, v3
    s_nop 0
    s_cmp_ge_u32 s79, 4
    s_cbranch_scc1 L_lwd_4
    s_sleep 1
    s_sub_u32 s81, s81, 1
    s_cmp_lg_u32 s81, 0
    s_cbranch_scc1 L_lw_3
L_lwd_4:
    v_and_b32 v3, 7, v0
    v_lshlrev_b32 v3, 4, v3
    s_mul_i32 s78, s74, 384
    v_add_u32 v3, s78, v3
    ds_read_b128 v[24:27], v3 offset:54272
    ds_read_b128 v[28:31], v3 offset:54400
    ds_read_b128 v[32:35], v3 offset:54528
    ds_read_b64 v[8:9], v2 offset:63512
    s_waitcnt lgkmcnt(0)
    v_dot2_f32_bf16 v3, v64, v24, 0
    v_dot2_f32_bf16 v4, v70, v30, 0
    v_dot2_f32_bf16 v3, v65, v25, v3
    v_dot2_f32_bf16 v4, v71, v31, v4
    v_dot2_f32_bf16 v3, v66, v26, v3
    v_dot2_f32_bf16 v4, v72, v32, v4
    v_dot2_f32_bf16 v3, v67, v27, v3
    v_dot2_f32_bf16 v4, v73, v33, v4
    v_dot2_f32_bf16 v3, v68, v28, v3
    v_dot2_f32_bf16 v4, v74, v34, v4
    v_dot2_f32_bf16 v3, v69, v29, v3
    v_dot2_f32_bf16 v4, v75, v35, v4
    buffer_load_dwordx4 v[64:67], v1, s[32:35], s75 offen offset:0 nt
    buffer_load_dwordx4 v[68:71], v1, s[32:35], s75 offen offset:128 nt
    buffer_load_dwordx4 v[72:75], v1, s[32:35], s75 offen offset:256 nt
    v_add_f32 v3, v3, v4
    s_nop 1
    v_add_f32_dpp v3, v3, v3 quad_perm:[1,0,3,2] row_mask:0xf bank_mask:0xf
    s_nop 1
    v_add_f32_dpp v3, v3, v3 quad_perm:[2,3,0,1] row_mask:0xf bank_mask:0xf
    s_nop 1
    v_add_f32_dpp v3, v3, v3 row_half_mirror row_mask:0xf bank_mask:0xf
    v_cvt_pk_bf16_f32 v4, v3, v3
    v_lshlrev_b32 v4, 16, v4
    v_mul_f32 v4, 0x3d93cd3a, v4
    v_cvt_pk_bf16_f32 v4, v4, v4
    v_lshlrev_b32 v4, 16, v4
    v_max_f32 v5, v11, v4
    v_sub_f32 v6, v11, v5
    v_sub_f32 v7, v4, v5
    v_mul_f32 v6, 0x3fb8aa3b, v6
    v_mul_f32 v7, 0x3fb8aa3b, v7
    v_exp_f32 v14, v6
    v_exp_f32 v16, v7
    v_mov_b32 v11, v5
    v_fma_f32 v12, v12, v14, v16
    v_pk_mul_f32 v[36:37], v[36:37], v[14:15] op_sel_hi:[1,0]
    v_pk_mul_f32 v[38:39], v[38:39], v[14:15] op_sel_hi:[1,0]
    v_pk_mul_f32 v[40:41], v[40:41], v[14:15] op_sel_hi:[1,0]
    v_pk_mul_f32 v[42:43], v[42:43], v[14:15] op_sel_hi:[1,0]
    v_pk_mul_f32 v[44:45], v[44:45], v[14:15] op_sel_hi:[1,0]
    v_pk_mul_f32 v[46:47], v[46:47], v[14:15] op_sel_hi:[1,0]
    v_pk_mul_f32 v[48:49], v[48:49], v[14:15] op_sel_hi:[1,0]
    v_pk_mul_f32 v[50:51], v[50:51], v[14:15] op_sel_hi:[1,0]
    v_pk_mul_f32 v[52:53], v[52:53], v[14:15] op_sel_hi:[1,0]
    v_pk_mul_f32 v[54:55], v[54:55], v[14:15] op_sel_hi:[1,0]
    v_pk_mul_f32 v[56:57], v[56:57], v[14:15] op_sel_hi:[1,0]
    v_pk_mul_f32 v[58:59], v[58:59], v[14:15] op_sel_hi:[1,0]
    v_lshlrev_b32 v18, 16, v76
    v_and_b32 v19, 0xffff0000, v76
    v_pk_fma_f32 v[36:37], v[18:19], v[16:17], v[36:37] op_sel_hi:[1,0,1]
    v_lshlrev_b32 v20, 16, v77
    v_and_b32 v21, 0xffff0000, v77
    v_pk_fma_f32 v[38:39], v[20:21], v[16:17], v[38:39] op_sel_hi:[1,0,1]
    v_lshlrev_b32 v18, 16, v78
    v_and_b32 v19, 0xffff0000, v78
    v_pk_fma_f32 v[40:41], v[18:19], v[16:17], v[40:41] op_sel_hi:[1,0,1]
    v_lshlrev_b32 v20, 16, v79
    v_and_b32 v21, 0xffff0000, v79
    v_pk_fma_f32 v[42:43], v[20:21], v[16:17], v[42:43] op_sel_hi:[1,0,1]
    v_lshlrev_b32 v18, 16, v80
    v_and_b32 v19, 0xffff0000, v80
    v_pk_fma_f32 v[44:45], v[18:19], v[16:17], v[44:45] op_sel_hi:[1,0,1]
    v_lshlrev_b32 v20, 16, v81
    v_and_b32 v21, 0xffff0000, v81
    v_pk_fma_f32 v[46:47], v[20:21], v[16:17], v[46:47] op_sel_hi:[1,0,1]
    v_lshlrev_b32 v18, 16, v82
    v_and_b32 v19, 0xffff0000, v82
    v_pk_fma_f32 v[48:49], v[18:19], v[16:17], v[48:49] op_sel_hi:[1,0,1]
    v_lshlrev_b32 v20, 16, v83
    v_and_b32 v21, 0xffff0000, v83
    v_pk_fma_f32 v[50:51], v[20:21], v[16:17], v[50:51] op_sel_hi:[1,0,1]
    v_lshlrev_b32 v18, 16, v84
    v_and_b32 v19, 0xffff0000, v84
    v_pk_fma_f32 v[52:53], v[18:19], v[16:17], v[52:53] op_sel_hi:[1,0,1]
    v_lshlrev_b32 v20, 16, v85
    v_and_b32 v21, 0xffff0000, v85
    v_pk_fma_f32 v[54:55], v[20:21], v[16:17], v[54:55] op_sel_hi:[1,0,1]
    v_lshlrev_b32 v18, 16, v86
    v_and_b32 v19, 0xffff0000, v86
    v_pk_fma_f32 v[56:57], v[18:19], v[16:17], v[56:57] op_sel_hi:[1,0,1]
    v_lshlrev_b32 v20, 16, v87
    v_and_b32 v21, 0xffff0000, v87
    v_pk_fma_f32 v[58:59], v[20:21], v[16:17], v[58:59] op_sel_hi:[1,0,1]
    buffer_load_dwordx4 v[76:79], v1, s[36:39], s75 offen offset:0 nt
    buffer_load_dwordx4 v[80:83], v1, s[36:39], s75 offen offset:128 nt
    buffer_load_dwordx4 v[84:87], v1, s[36:39], s75 offen offset:256 nt
    s_add_u32 s75, s75, 24576
    v_dot2_f32_bf16 v3, v88, v24, 0
    v_dot2_f32_bf16 v4, v94, v30, 0
    v_dot2_f32_bf16 v3, v89, v25, v3
    v_dot2_f32_bf16 v4, v95, v31, v4
    v_dot2_f32_bf16 v3, v90, v26, v3
    v_dot2_f32_bf16 v4, v96, v32, v4
    v_dot2_f32_bf16 v3, v91, v27, v3
    v_dot2_f32_bf16 v4, v97, v33, v4
    v_dot2_f32_bf16 v3, v92, v28, v3
    v_dot2_f32_bf16 v4, v98, v34, v4
    v_dot2_f32_bf16 v3, v93, v29, v3
    v_dot2_f32_bf16 v4, v99, v35, v4
    buffer_load_dwordx4 v[88:91], v1, s[32:35], s75 offen offset:0 nt
    buffer_load_dwordx4 v[92:95], v1, s[32:35], s75 offen offset:128 nt
    buffer_load_dwordx4 v[96:99], v1, s[32:35], s75 offen offset:256 nt
    v_add_f32 v3, v3, v4
    s_nop 1
    v_add_f32_dpp v3, v3, v3 quad_perm:[1,0,3,2] row_mask:0xf bank_mask:0xf
    s_nop 1
    v_add_f32_dpp v3, v3, v3 quad_perm:[2,3,0,1] row_mask:0xf bank_mask:0xf
    s_nop 1
    v_add_f32_dpp v3, v3, v3 row_half_mirror row_mask:0xf bank_mask:0xf
    v_cvt_pk_bf16_f32 v4, v3, v3
    v_lshlrev_b32 v4, 16, v4
    v_mul_f32 v4, 0x3d93cd3a, v4
    v_cvt_pk_bf16_f32 v4, v4, v4
    v_lshlrev_b32 v4, 16, v4
    v_max_f32 v5, v11, v4
    v_sub_f32 v6, v11, v5
    v_sub_f32 v7, v4, v5
    v_mul_f32 v6, 0x3fb8aa3b, v6
    v_mul_f32 v7, 0x3fb8aa3b, v7
    v_exp_f32 v14, v6
    v_exp_f32 v16, v7
    v_mov_b32 v11, v5
    v_fma_f32 v12, v12, v14, v16
    v_pk_mul_f32 v[36:37], v[36:37], v[14:15] op_sel_hi:[1,0]
    v_pk_mul_f32 v[38:39], v[38:39], v[14:15] op_sel_hi:[1,0]
    v_pk_mul_f32 v[40:41], v[40:41], v[14:15] op_sel_hi:[1,0]
    v_pk_mul_f32 v[42:43], v[42:43], v[14:15] op_sel_hi:[1,0]
    v_pk_mul_f32 v[44:45], v[44:45], v[14:15] op_sel_hi:[1,0]
    v_pk_mul_f32 v[46:47], v[46:47], v[14:15] op_sel_hi:[1,0]
    v_pk_mul_f32 v[48:49], v[48:49], v[14:15] op_sel_hi:[1,0]
    v_pk_mul_f32 v[50:51], v[50:51], v[14:15] op_sel_hi:[1,0]
    v_pk_mul_f32 v[52:53], v[52:53], v[14:15] op_sel_hi:[1,0]
    v_pk_mul_f32 v[54:55], v[54:55], v[14:15] op_sel_hi:[1,0]
    v_pk_mul_f32 v[56:57], v[56:57], v[14:15] op_sel_hi:[1,0]
    v_pk_mul_f32 v[58:59], v[58:59], v[14:15] op_sel_hi:[1,0]
    v_lshlrev_b32 v18, 16, v100
    v_and_b32 v19, 0xffff0000, v100
    v_pk_fma_f32 v[36:37], v[18:19], v[16:17], v[36:37] op_sel_hi:[1,0,1]
    v_lshlrev_b32 v20, 16, v101
    v_and_b32 v21, 0xffff0000, v101
    v_pk_fma_f32 v[38:39], v[20:21], v[16:17], v[38:39] op_sel_hi:[1,0,1]
    v_lshlrev_b32 v18, 16, v102
    v_and_b32 v19, 0xffff0000, v102
    v_pk_fma_f32 v[40:41], v[18:19], v[16:17], v[40:41] op_sel_hi:[1,0,1]
    v_lshlrev_b32 v20, 16, v103
    v_and_b32 v21, 0xffff0000, v103
    v_pk_fma_f32 v[42:43], v[20:21], v[16:17], v[42:43] op_sel_hi:[1,0,1]
    v_lshlrev_b32 v18, 16, v104
    v_and_b32 v19, 0xffff0000, v104
    v_pk_fma_f32 v[44:45], v[18:19], v[16:17], v[44:45] op_sel_hi:[1,0,1]
    v_lshlrev_b32 v20, 16, v105
    v_and_b32 v21, 0xffff0000, v105
    v_pk_fma_f32 v[46:47], v[20:21], v[16:17], v[46:47] op_sel_hi:[1,0,1]
    v_lshlrev_b32 v18, 16, v106
    v_and_b32 v19, 0xffff0000, v106
    v_pk_fma_f32 v[48:49], v[18:19], v[16:17], v[48:49] op_sel_hi:[1,0,1]
    v_lshlrev_b32 v20, 16, v107
    v_and_b32 v21, 0xffff0000, v107
    v_pk_fma_f32 v[50:51], v[20:21], v[16:17], v[50:51] op_sel_hi:[1,0,1]
    v_lshlrev_b32 v18, 16, v108
    v_and_b32 v19, 0xffff0000, v108
    v_pk_fma_f32 v[52:53], v[18:19], v[16:17], v[52:53] op_sel_hi:[1,0,1]
    v_lshlrev_b32 v20, 16, v109
    v_and_b32 v21, 0xffff0000, v109
    v_pk_fma_f32 v[54:55], v[20:21], v[16:17], v[54:55] op_sel_hi:[1,0,1]
    v_lshlrev_b32 v18, 16, v110
    v_and_b32 v19, 0xffff0000, v110
    v_pk_fma_f32 v[56:57], v[18:19], v[16:17], v[56:57] op_sel_hi:[1,0,1]
    v_lshlrev_b32 v20, 16, v111
    v_and_b32 v21, 0xffff0000, v111
    v_pk_fma_f32 v[58:59], v[20:21], v[16:17], v[58:59] op_sel_hi:[1,0,1]
    buffer_load_dwordx4 v[100:103], v1, s[36:39], s75 offen offset:0 nt
    buffer_load_dwordx4 v[104:107], v1, s[36:39], s75 offen offset:128 nt
    buffer_load_dwordx4 v[108:111], v1, s[36:39], s75 offen offset:256 nt
    s_add_u32 s75, s75, 24576
    v_dot2_f32_bf16 v3, v112, v24, 0
    v_dot2_f32_bf16 v4, v118, v30, 0
    v_dot2_f32_bf16 v3, v113, v25, v3
    v_dot2_f32_bf16 v4, v119, v31, v4
    v_dot2_f32_bf16 v3, v114, v26, v3
    v_dot2_f32_bf16 v4, v120, v32, v4
    v_dot2_f32_bf16 v3, v115, v27, v3
    v_dot2_f32_bf16 v4, v121, v33, v4
    v_dot2_f32_bf16 v3, v116, v28, v3
    v_dot2_f32_bf16 v4, v122, v34, v4
    v_dot2_f32_bf16 v3, v117, v29, v3
    v_dot2_f32_bf16 v4, v123, v35, v4
    s_nop 2
    v_add_f32 v3, v3, v4
    s_nop 1
    v_add_f32_dpp v3, v3, v3 quad_perm:[1,0,3,2] row_mask:0xf bank_mask:0xf
    s_nop 1
    v_add_f32_dpp v3, v3, v3 quad_perm:[2,3,0,1] row_mask:0xf bank_mask:0xf
    s_nop 1
    v_add_f32_dpp v3, v3, v3 row_half_mirror row_mask:0xf bank_mask:0xf
    v_cvt_pk_bf16_f32 v4, v3, v3
    v_lshlrev_b32 v4, 16, v4
    v_mul_f32 v4, 0x3d93cd3a, v4
    v_cvt_pk_bf16_f32 v4, v4, v4
    v_lshlrev_b32 v4, 16, v4
    v_max_f32 v5, v11, v4
    v_sub_f32 v6, v11, v5
    v_sub_f32 v7, v4, v5
    v_mul_f32 v6, 0x3fb8aa3b, v6
    v_mul_f32 v7, 0x3fb8aa3b, v7
    v_exp_f32 v14, v6
    v_exp_f32 v16, v7
    v_mov_b32 v11, v5
    v_fma_f32 v12, v12, v14, v16
    v_pk_mul_f32 v[36:37], v[36:37], v[14:15] op_sel_hi:[1,0]
    v_pk_mul_f32 v[38:39], v[38:39], v[14:15] op_sel_hi:[1,0]
    v_pk_mul_f32 v[40:41], v[40:41], v[14:15] op_sel_hi:[1,0]
    v_pk_mul_f32 v[42:43], v[42:43], v[14:15] op_sel_hi:[1,0]
    v_pk_mul_f32 v[44:45], v[44:45], v[14:15] op_sel_hi:[1,0]
    v_pk_mul_f32 v[46:47], v[46:47], v[14:15] op_sel_hi:[1,0]
    v_pk_mul_f32 v[48:49], v[48:49], v[14:15] op_sel_hi:[1,0]
    v_pk_mul_f32 v[50:51], v[50:51], v[14:15] op_sel_hi:[1,0]
    v_pk_mul_f32 v[52:53], v[52:53], v[14:15] op_sel_hi:[1,0]
    v_pk_mul_f32 v[54:55], v[54:55], v[14:15] op_sel_hi:[1,0]
    v_pk_mul_f32 v[56:57], v[56:57], v[14:15] op_sel_hi:[1,0]
    v_pk_mul_f32 v[58:59], v[58:59], v[14:15] op_sel_hi:[1,0]
    v_lshlrev_b32 v18, 16, v124
    v_and_b32 v19, 0xffff0000, v124
    v_pk_fma_f32 v[36:37], v[18:19], v[16:17], v[36:37] op_sel_hi:[1,0,1]
    v_lshlrev_b32 v20, 16, v125
    v_and_b32 v21, 0xffff0000, v125
    v_pk_fma_f32 v[38:39], v[20:21], v[16:17], v[38:39] op_sel_hi:[1,0,1]
    v_lshlrev_b32 v18, 16, v126
    v_and_b32 v19, 0xffff0000, v126
    v_pk_fma_f32 v[40:41], v[18:19], v[16:17], v[40:41] op_sel_hi:[1,0,1]
    v_lshlrev_b32 v20, 16, v127
    v_and_b32 v21, 0xffff0000, v127
    v_pk_fma_f32 v[42:43], v[20:21], v[16:17], v[42:43] op_sel_hi:[1,0,1]
    v_lshlrev_b32 v18, 16, v128
    v_and_b32 v19, 0xffff0000, v128
    v_pk_fma_f32 v[44:45], v[18:19], v[16:17], v[44:45] op_sel_hi:[1,0,1]
    v_lshlrev_b32 v20, 16, v129
    v_and_b32 v21, 0xffff0000, v129
    v_pk_fma_f32 v[46:47], v[20:21], v[16:17], v[46:47] op_sel_hi:[1,0,1]
    v_lshlrev_b32 v18, 16, v130
    v_and_b32 v19, 0xffff0000, v130
    v_pk_fma_f32 v[48:49], v[18:19], v[16:17], v[48:49] op_sel_hi:[1,0,1]
    v_lshlrev_b32 v20, 16, v131
    v_and_b32 v21, 0xffff0000, v131
    v_pk_fma_f32 v[50:51], v[20:21], v[16:17], v[50:51] op_sel_hi:[1,0,1]
    v_lshlrev_b32 v18, 16, v132
    v_and_b32 v19, 0xffff0000, v132
    v_pk_fma_f32 v[52:53], v[18:19], v[16:17], v[52:53] op_sel_hi:[1,0,1]
    v_lshlrev_b32 v20, 16, v133
    v_and_b32 v21, 0xffff0000, v133
    v_pk_fma_f32 v[54:55], v[20:21], v[16:17], v[54:55] op_sel_hi:[1,0,1]
    v_lshlrev_b32 v18, 16, v134
    v_and_b32 v19, 0xffff0000, v134
    v_pk_fma_f32 v[56:57], v[18:19], v[16:17], v[56:57] op_sel_hi:[1,0,1]
    v_lshlrev_b32 v20, 16, v135
    v_and_b32 v21, 0xffff0000, v135
    v_pk_fma_f32 v[58:59], v[20:21], v[16:17], v[58:59] op_sel_hi:[1,0,1]
    ds_read_b128 v[112:115], v22 offset:0
    ds_read_b128 v[116:119], v22 offset:1024
    ds_read_b128 v[120:123], v22 offset:2048
    ds_read_b128 v[124:127], v22 offset:3072
    ds_read_b128 v[128:131], v22 offset:4096
    ds_read_b128 v[132:135], v22 offset:5120
    v_dot2_f32_bf16 v3, v136, v24, 0
    v_dot2_f32_bf16 v4, v142, v30, 0
    v_dot2_f32_bf16 v3, v137, v25, v3
    v_dot2_f32_bf16 v4, v143, v31, v4
    v_dot2_f32_bf16 v3, v138, v26, v3
    v_dot2_f32_bf16 v4, v144, v32, v4
    v_dot2_f32_bf16 v3, v139, v27, v3
    v_dot2_f32_bf16 v4, v145, v33, v4
    v_dot2_f32_bf16 v3, v140, v28, v3
    v_dot2_f32_bf16 v4, v146, v34, v4
    v_dot2_f32_bf16 v3, v141, v29, v3
    v_dot2_f32_bf16 v4, v147, v35, v4
    s_nop 2
    v_add_f32 v3, v3, v4
    s_nop 1
    v_add_f32_dpp v3, v3, v3 quad_perm:[1,0,3,2] row_mask:0xf bank_mask:0xf
    s_nop 1
    v_add_f32_dpp v3, v3, v3 quad_perm:[2,3,0,1] row_mask:0xf bank_mask:0xf
    s_nop 1
    v_add_f32_dpp v3, v3, v3 row_half_mirror row_mask:0xf bank_mask:0xf
    v_cvt_pk_bf16_f32 v4, v3, v3
    v_lshlrev_b32 v4, 16, v4
    v_mul_f32 v4, 0x3d93cd3a, v4
    v_cvt_pk_bf16_f32 v4, v4, v4
    v_lshlrev_b32 v4, 16, v4
    v_max_f32 v5, v11, v4
    v_sub_f32 v6, v11, v5
    v_sub_f32 v7, v4, v5
    v_mul_f32 v6, 0x3fb8aa3b, v6
    v_mul_f32 v7, 0x3fb8aa3b, v7
    v_exp_f32 v14, v6
    v_exp_f32 v16, v7
    v_mov_b32 v11, v5
    v_fma_f32 v12, v12, v14, v16
    v_pk_mul_f32 v[36:37], v[36:37], v[14:15] op_sel_hi:[1,0]
    v_pk_mul_f32 v[38:39], v[38:39], v[14:15] op_sel_hi:[1,0]
    v_pk_mul_f32 v[40:41], v[40:41], v[14:15] op_sel_hi:[1,0]
    v_pk_mul_f32 v[42:43], v[42:43], v[14:15] op_sel_hi:[1,0]
    v_pk_mul_f32 v[44:45], v[44:45], v[14:15] op_sel_hi:[1,0]
    v_pk_mul_f32 v[46:47], v[46:47], v[14:15] op_sel_hi:[1,0]
    v_pk_mul_f32 v[48:49], v[48:49], v[14:15] op_sel_hi:[1,0]
    v_pk_mul_f32 v[50:51], v[50:51], v[14:15] op_sel_hi:[1,0]
    v_pk_mul_f32 v[52:53], v[52:53], v[14:15] op_sel_hi:[1,0]
    v_pk_mul_f32 v[54:55], v[54:55], v[14:15] op_sel_hi:[1,0]
    v_pk_mul_f32 v[56:57], v[56:57], v[14:15] op_sel_hi:[1,0]
    v_pk_mul_f32 v[58:59], v[58:59], v[14:15] op_sel_hi:[1,0]
    v_lshlrev_b32 v18, 16, v148
    v_and_b32 v19, 0xffff0000, v148
    v_pk_fma_f32 v[36:37], v[18:19], v[16:17], v[36:37] op_sel_hi:[1,0,1]
    v_lshlrev_b32 v20, 16, v149
    v_and_b32 v21, 0xffff0000, v149
    v_pk_fma_f32 v[38:39], v[20:21], v[16:17], v[38:39] op_sel_hi:[1,0,1]
    v_lshlrev_b32 v18, 16, v150
    v_and_b32 v19, 0xffff0000, v150
    v_pk_fma_f32 v[40:41], v[18:19], v[16:17], v[40:41] op_sel_hi:[1,0,1]
    v_lshlrev_b32 v20, 16, v151
    v_and_b32 v21, 0xffff0000, v151
    v_pk_fma_f32 v[42:43], v[20:21], v[16:17], v[42:43] op_sel_hi:[1,0,1]
    v_lshlrev_b32 v18, 16, v152
    v_and_b32 v19, 0xffff0000, v152
    v_pk_fma_f32 v[44:45], v[18:19], v[16:17], v[44:45] op_sel_hi:[1,0,1]
    v_lshlrev_b32 v20, 16, v153
    v_and_b32 v21, 0xffff0000, v153
    v_pk_fma_f32 v[46:47], v[20:21], v[16:17], v[46:47] op_sel_hi:[1,0,1]
    v_lshlrev_b32 v18, 16, v154
    v_and_b32 v19, 0xffff0000, v154
    v_pk_fma_f32 v[48:49], v[18:19], v[16:17], v[48:49] op_sel_hi:[1,0,1]
    v_lshlrev_b32 v20, 16, v155
    v_and_b32 v21, 0xffff0000, v155
    v_pk_fma_f32 v[50:51], v[20:21], v[16:17], v[50:51] op_sel_hi:[1,0,1]
    v_lshlrev_b32 v18, 16, v156
    v_and_b32 v19, 0xffff0000, v156
    v_pk_fma_f32 v[52:53], v[18:19], v[16:17], v[52:53] op_sel_hi:[1,0,1]
    v_lshlrev_b32 v20, 16, v157
    v_and_b32 v21, 0xffff0000, v157
    v_pk_fma_f32 v[54:55], v[20:21], v[16:17], v[54:55] op_sel_hi:[1,0,1]
    v_lshlrev_b32 v18, 16, v158
    v_and_b32 v19, 0xffff0000, v158
    v_pk_fma_f32 v[56:57], v[18:19], v[16:17], v[56:57] op_sel_hi:[1,0,1]
    v_lshlrev_b32 v20, 16, v159
    v_and_b32 v21, 0xffff0000, v159
    v_pk_fma_f32 v[58:59], v[20:21], v[16:17], v[58:59] op_sel_hi:[1,0,1]
    ds_read_b128 v[136:139], v22 offset:6144
    ds_read_b128 v[140:143], v22 offset:7168
    ds_read_b128 v[144:147], v22 offset:8192
    ds_read_b128 v[148:151], v22 offset:9216
    ds_read_b128 v[152:155], v22 offset:10240
    ds_read_b128 v[156:159], v22 offset:11264
    s_waitcnt vmcnt(9)
    v_dot2_f32_bf16 v3, v64, v24, 0
    v_dot2_f32_bf16 v4, v70, v30, 0
    v_dot2_f32_bf16 v3, v65, v25, v3
    v_dot2_f32_bf16 v4, v71, v31, v4
    v_dot2_f32_bf16 v3, v66, v26, v3
    v_dot2_f32_bf16 v4, v72, v32, v4
    v_dot2_f32_bf16 v3, v67, v27, v3
    v_dot2_f32_bf16 v4, v73, v33, v4
    v_dot2_f32_bf16 v3, v68, v28, v3
    v_dot2_f32_bf16 v4, v74, v34, v4
    v_dot2_f32_bf16 v3, v69, v29, v3
    v_dot2_f32_bf16 v4, v75, v35, v4
    buffer_load_dwordx4 v[64:67], v1, s[32:35], s75 offen offset:0 nt
    buffer_load_dwordx4 v[68:71], v1, s[32:35], s75 offen offset:128 nt
    buffer_load_dwordx4 v[72:75], v1, s[32:35], s75 offen offset:256 nt
    v_add_f32 v3, v3, v4
    s_nop 1
    v_add_f32_dpp v3, v3, v3 quad_perm:[1,0,3,2] row_mask:0xf bank_mask:0xf
    s_nop 1
    v_add_f32_dpp v3, v3, v3 quad_perm:[2,3,0,1] row_mask:0xf bank_mask:0xf
    s_nop 1
    v_add_f32_dpp v3, v3, v3 row_half_mirror row_mask:0xf bank_mask:0xf
    v_cvt_pk_bf16_f32 v4, v3, v3
    v_lshlrev_b32 v4, 16, v4
    v_mul_f32 v4, 0x3d93cd3a, v4
    v_cvt_pk_bf16_f32 v4, v4, v4
    v_lshlrev_b32 v4, 16, v4
    v_max_f32 v5, v11, v4
    v_sub_f32 v6, v11, v5
    v_sub_f32 v7, v4, v5
    v_mul_f32 v6, 0x3fb8aa3b, v6
    v_mul_f32 v7, 0x3fb8aa3b, v7
    v_exp_f32 v14, v6
    v_exp_f32 v16, v7
    v_mov_b32 v11, v5
    v_fma_f32 v12, v12, v14, v16
    v_pk_mul_f32 v[36:37], v[36:37], v[14:15] op_sel_hi:[1,0]
    v_pk_mul_f32 v[38:39], v[38:39], v[14:15] op_sel_hi:[1,0]
    v_pk_mul_f32 v[40:41], v[40:41], v[14:15] op_sel_hi:[1,0]
    v_pk_mul_f32 v[42:43], v[42:43], v[14:15] op_sel_hi:[1,0]
    v_pk_mul_f32 v[44:45], v[44:45], v[14:15] op_sel_hi:[1,0]
    v_pk_mul_f32 v[46:47], v[46:47], v[14:15] op_sel_hi:[1,0]
    v_pk_mul_f32 v[48:49], v[48:49], v[14:15] op_sel_hi:[1,0]
    v_pk_mul_f32 v[50:51], v[50:51], v[14:15] op_sel_hi:[1,0]
    v_pk_mul_f32 v[52:53], v[52:53], v[14:15] op_sel_hi:[1,0]
    v_pk_mul_f32 v[54:55], v[54:55], v[14:15] op_sel_hi:[1,0]
    v_pk_mul_f32 v[56:57], v[56:57], v[14:15] op_sel_hi:[1,0]
    v_pk_mul_f32 v[58:59], v[58:59], v[14:15] op_sel_hi:[1,0]
    s_waitcnt vmcnt(9)
    v_lshlrev_b32 v18, 16, v76
    v_and_b32 v19, 0xffff0000, v76
    v_pk_fma_f32 v[36:37], v[18:19], v[16:17], v[36:37] op_sel_hi:[1,0,1]
    v_lshlrev_b32 v20, 16, v77
    v_and_b32 v21, 0xffff0000, v77
    v_pk_fma_f32 v[38:39], v[20:21], v[16:17], v[38:39] op_sel_hi:[1,0,1]
    v_lshlrev_b32 v18, 16, v78
    v_and_b32 v19, 0xffff0000, v78
    v_pk_fma_f32 v[40:41], v[18:19], v[16:17], v[40:41] op_sel_hi:[1,0,1]
    v_lshlrev_b32 v20, 16, v79
    v_and_b32 v21, 0xffff0000, v79
    v_pk_fma_f32 v[42:43], v[20:21], v[16:17], v[42:43] op_sel_hi:[1,0,1]
    v_lshlrev_b32 v18, 16, v80
    v_and_b32 v19, 0xffff0000, v80
    v_pk_fma_f32 v[44:45], v[18:19], v[16:17], v[44:45] op_sel_hi:[1,0,1]
    v_lshlrev_b32 v20, 16, v81
    v_and_b32 v21, 0xffff0000, v81
    v_pk_fma_f32 v[46:47], v[20:21], v[16:17], v[46:47] op_sel_hi:[1,0,1]
    v_lshlrev_b32 v18, 16, v82
    v_and_b32 v19, 0xffff0000, v82
    v_pk_fma_f32 v[48:49], v[18:19], v[16:17], v[48:49] op_sel_hi:[1,0,1]
    v_lshlrev_b32 v20, 16, v83
    v_and_b32 v21, 0xffff0000, v83
    v_pk_fma_f32 v[50:51], v[20:21], v[16:17], v[50:51] op_sel_hi:[1,0,1]
    v_lshlrev_b32 v18, 16, v84
    v_and_b32 v19, 0xffff0000, v84
    v_pk_fma_f32 v[52:53], v[18:19], v[16:17], v[52:53] op_sel_hi:[1,0,1]
    v_lshlrev_b32 v20, 16, v85
    v_and_b32 v21, 0xffff0000, v85
    v_pk_fma_f32 v[54:55], v[20:21], v[16:17], v[54:55] op_sel_hi:[1,0,1]
    v_lshlrev_b32 v18, 16, v86
    v_and_b32 v19, 0xffff0000, v86
    v_pk_fma_f32 v[56:57], v[18:19], v[16:17], v[56:57] op_sel_hi:[1,0,1]
    v_lshlrev_b32 v20, 16, v87
    v_and_b32 v21, 0xffff0000, v87
    v_pk_fma_f32 v[58:59], v[20:21], v[16:17], v[58:59] op_sel_hi:[1,0,1]
    buffer_load_dwordx4 v[76:79], v1, s[36:39], s75 offen offset:0 nt
    buffer_load_dwordx4 v[80:83], v1, s[36:39], s75 offen offset:128 nt
    buffer_load_dwordx4 v[84:87], v1, s[36:39], s75 offen offset:256 nt
    s_add_u32 s75, s75, 24576
    v_dot2_f32_bf16 v3, v160, v24, 0
    v_dot2_f32_bf16 v4, v166, v30, 0
    v_dot2_f32_bf16 v3, v161, v25, v3
    v_dot2_f32_bf16 v4, v167, v31, v4
    v_dot2_f32_bf16 v3, v162, v26, v3
    v_dot2_f32_bf16 v4, v168, v32, v4
    v_dot2_f32_bf16 v3, v163, v27, v3
    v_dot2_f32_bf16 v4, v169, v33, v4
    v_dot2_f32_bf16 v3, v164, v28, v3
    v_dot2_f32_bf16 v4, v170, v34, v4
    v_dot2_f32_bf16 v3, v165, v29, v3
    v_dot2_f32_bf16 v4, v171, v35, v4
    s_nop 2
    v_add_f32 v3, v3, v4
    s_nop 1
    v_add_f32_dpp v3, v3, v3 quad_perm:[1,0,3,2] row_mask:0xf bank_mask:0xf
    s_nop 1
    v_add_f32_dpp v3, v3, v3 quad_perm:[2,3,0,1] row_mask:0xf bank_mask:0xf
    s_nop 1
    v_add_f32_dpp v3, v3, v3 row_half_mirror row_mask:0xf bank_mask:0xf
    v_cvt_pk_bf16_f32 v4, v3, v3
    v_lshlrev_b32 v4, 16, v4
    v_mul_f32 v4, 0x3d93cd3a, v4
    v_cvt_pk_bf16_f32 v4, v4, v4
    v_lshlrev_b32 v4, 16, v4
    v_max_f32 v5, v11, v4
    v_sub_f32 v6, v11, v5
    v_sub_f32 v7, v4, v5
    v_mul_f32 v6, 0x3fb8aa3b, v6
    v_mul_f32 v7, 0x3fb8aa3b, v7
    v_exp_f32 v14, v6
    v_exp_f32 v16, v7
    v_mov_b32 v11, v5
    v_fma_f32 v12, v12, v14, v16
    v_pk_mul_f32 v[36:37], v[36:37], v[14:15] op_sel_hi:[1,0]
    v_pk_mul_f32 v[38:39], v[38:39], v[14:15] op_sel_hi:[1,0]
    v_pk_mul_f32 v[40:41], v[40:41], v[14:15] op_sel_hi:[1,0]
    v_pk_mul_f32 v[42:43], v[42:43], v[14:15] op_sel_hi:[1,0]
    v_pk_mul_f32 v[44:45], v[44:45], v[14:15] op_sel_hi:[1,0]
    v_pk_mul_f32 v[46:47], v[46:47], v[14:15] op_sel_hi:[1,0]
    v_pk_mul_f32 v[48:49], v[48:49], v[14:15] op_sel_hi:[1,0]
    v_pk_mul_f32 v[50:51], v[50:51], v[14:15] op_sel_hi:[1,0]
    v_pk_mul_f32 v[52:53], v[52:53], v[14:15] op_sel_hi:[1,0]
    v_pk_mul_f32 v[54:55], v[54:55], v[14:15] op_sel_hi:[1,0]
    v_pk_mul_f32 v[56:57], v[56:57], v[14:15] op_sel_hi:[1,0]
    v_pk_mul_f32 v[58:59], v[58:59], v[14:15] op_sel_hi:[1,0]
    v_lshlrev_b32 v18, 16, v172
    v_and_b32 v19, 0xffff0000, v172
    v_pk_fma_f32 v[36:37], v[18:19], v[16:17], v[36:37] op_sel_hi:[1,0,1]
    v_lshlrev_b32 v20, 16, v173
    v_and_b32 v21, 0xffff0000, v173
    v_pk_fma_f32 v[38:39], v[20:21], v[16:17], v[38:39] op_sel_hi:[1,0,1]
    v_lshlrev_b32 v18, 16, v174
    v_and_b32 v19, 0xffff0000, v174
    v_pk_fma_f32 v[40:41], v[18:19], v[16:17], v[40:41] op_sel_hi:[1,0,1]
    v_lshlrev_b32 v20, 16, v175
    v_and_b32 v21, 0xffff0000, v175
    v_pk_fma_f32 v[42:43], v[20:21], v[16:17], v[42:43] op_sel_hi:[1,0,1]
    v_lshlrev_b32 v18, 16, v176
    v_and_b32 v19, 0xffff0000, v176
    v_pk_fma_f32 v[44:45], v[18:19], v[16:17], v[44:45] op_sel_hi:[1,0,1]
    v_lshlrev_b32 v20, 16, v177
    v_and_b32 v21, 0xffff0000, v177
    v_pk_fma_f32 v[46:47], v[20:21], v[16:17], v[46:47] op_sel_hi:[1,0,1]
    v_lshlrev_b32 v18, 16, v178
    v_and_b32 v19, 0xffff0000, v178
    v_pk_fma_f32 v[48:49], v[18:19], v[16:17], v[48:49] op_sel_hi:[1,0,1]
    v_lshlrev_b32 v20, 16, v179
    v_and_b32 v21, 0xffff0000, v179
    v_pk_fma_f32 v[50:51], v[20:21], v[16:17], v[50:51] op_sel_hi:[1,0,1]
    v_lshlrev_b32 v18, 16, v180
    v_and_b32 v19, 0xffff0000, v180
    v_pk_fma_f32 v[52:53], v[18:19], v[16:17], v[52:53] op_sel_hi:[1,0,1]
    v_lshlrev_b32 v20, 16, v181
    v_and_b32 v21, 0xffff0000, v181
    v_pk_fma_f32 v[54:55], v[20:21], v[16:17], v[54:55] op_sel_hi:[1,0,1]
    v_lshlrev_b32 v18, 16, v182
    v_and_b32 v19, 0xffff0000, v182
    v_pk_fma_f32 v[56:57], v[18:19], v[16:17], v[56:57] op_sel_hi:[1,0,1]
    v_lshlrev_b32 v20, 16, v183
    v_and_b32 v21, 0xffff0000, v183
    v_pk_fma_f32 v[58:59], v[20:21], v[16:17], v[58:59] op_sel_hi:[1,0,1]
    ds_read_b128 v[160:163], v22 offset:12288
    ds_read_b128 v[164:167], v22 offset:13312
    ds_read_b128 v[168:171], v22 offset:14336
    ds_read_b128 v[172:175], v22 offset:15360
    ds_read_b128 v[176:179], v22 offset:16384
    ds_read_b128 v[180:183], v22 offset:17408
    v_dot2_f32_bf16 v3, v184, v24, 0
    v_dot2_f32_bf16 v4, v190, v30, 0
    v_dot2_f32_bf16 v3, v185, v25, v3
    v_dot2_f32_bf16 v4, v191, v31, v4
    v_dot2_f32_bf16 v3, v186, v26, v3
    v_dot2_f32_bf16 v4, v192, v32, v4
    v_dot2_f32_bf16 v3, v187, v27, v3
    v_dot2_f32_bf16 v4, v193, v33, v4
    v_dot2_f32_bf16 v3, v188, v28, v3
    v_dot2_f32_bf16 v4, v194, v34, v4
    v_dot2_f32_bf16 v3, v189, v29, v3
    v_dot2_f32_bf16 v4, v195, v35, v4
    s_nop 2
    v_add_f32 v3, v3, v4
    s_nop 1
    v_add_f32_dpp v3, v3, v3 quad_perm:[1,0,3,2] row_mask:0xf bank_mask:0xf
    s_nop 1
    v_add_f32_dpp v3, v3, v3 quad_perm:[2,3,0,1] row_mask:0xf bank_mask:0xf
    s_nop 1
    v_add_f32_dpp v3, v3, v3 row_half_mirror row_mask:0xf bank_mask:0xf
    v_cvt_pk_bf16_f32 v4, v3, v3
    v_lshlrev_b32 v4, 16, v4
    v_mul_f32 v4, 0x3d93cd3a, v4
    v_cvt_pk_bf16_f32 v4, v4, v4
    v_lshlrev_b32 v4, 16, v4
    v_max_f32 v5, v11, v4
    v_sub_f32 v6, v11, v5
    v_sub_f32 v7, v4, v5
    v_mul_f32 v6, 0x3fb8aa3b, v6
    v_mul_f32 v7, 0x3fb8aa3b, v7
    v_exp_f32 v14, v6
    v_exp_f32 v16, v7
    v_mov_b32 v11, v5
    v_fma_f32 v12, v12, v14, v16
    v_pk_mul_f32 v[36:37], v[36:37], v[14:15] op_sel_hi:[1,0]
    v_pk_mul_f32 v[38:39], v[38:39], v[14:15] op_sel_hi:[1,0]
    v_pk_mul_f32 v[40:41], v[40:41], v[14:15] op_sel_hi:[1,0]
    v_pk_mul_f32 v[42:43], v[42:43], v[14:15] op_sel_hi:[1,0]
    v_pk_mul_f32 v[44:45], v[44:45], v[14:15] op_sel_hi:[1,0]
    v_pk_mul_f32 v[46:47], v[46:47], v[14:15] op_sel_hi:[1,0]
    v_pk_mul_f32 v[48:49], v[48:49], v[14:15] op_sel_hi:[1,0]
    v_pk_mul_f32 v[50:51], v[50:51], v[14:15] op_sel_hi:[1,0]
    v_pk_mul_f32 v[52:53], v[52:53], v[14:15] op_sel_hi:[1,0]
    v_pk_mul_f32 v[54:55], v[54:55], v[14:15] op_sel_hi:[1,0]
    v_pk_mul_f32 v[56:57], v[56:57], v[14:15] op_sel_hi:[1,0]
    v_pk_mul_f32 v[58:59], v[58:59], v[14:15] op_sel_hi:[1,0]
    v_lshlrev_b32 v18, 16, v196
    v_and_b32 v19, 0xffff0000, v196
    v_pk_fma_f32 v[36:37], v[18:19], v[16:17], v[36:37] op_sel_hi:[1,0,1]
    v_lshlrev_b32 v20, 16, v197
    v_and_b32 v21, 0xffff0000, v197
    v_pk_fma_f32 v[38:39], v[20:21], v[16:17], v[38:39] op_sel_hi:[1,0,1]
    v_lshlrev_b32 v18, 16, v198
    v_and_b32 v19, 0xffff0000, v198
    v_pk_fma_f32 v[40:41], v[18:19], v[16:17], v[40:41] op_sel_hi:[1,0,1]
    v_lshlrev_b32 v20, 16, v199
    v_and_b32 v21, 0xffff0000, v199
    v_pk_fma_f32 v[42:43], v[20:21], v[16:17], v[42:43] op_sel_hi:[1,0,1]
    v_lshlrev_b32 v18, 16, v200
    v_and_b32 v19, 0xffff0000, v200
    v_pk_fma_f32 v[44:45], v[18:19], v[16:17], v[44:45] op_sel_hi:[1,0,1]
    v_lshlrev_b32 v20, 16, v201
    v_and_b32 v21, 0xffff0000, v201
    v_pk_fma_f32 v[46:47], v[20:21], v[16:17], v[46:47] op_sel_hi:[1,0,1]
    v_lshlrev_b32 v18, 16, v202
    v_and_b32 v19, 0xffff0000, v202
    v_pk_fma_f32 v[48:49], v[18:19], v[16:17], v[48:49] op_sel_hi:[1,0,1]
    v_lshlrev_b32 v20, 16, v203
    v_and_b32 v21, 0xffff0000, v203
    v_pk_fma_f32 v[50:51], v[20:21], v[16:17], v[50:51] op_sel_hi:[1,0,1]
    v_lshlrev_b32 v18, 16, v204
    v_and_b32 v19, 0xffff0000, v204
    v_pk_fma_f32 v[52:53], v[18:19], v[16:17], v[52:53] op_sel_hi:[1,0,1]
    v_lshlrev_b32 v20, 16, v205
    v_and_b32 v21, 0xffff0000, v205
    v_pk_fma_f32 v[54:55], v[20:21], v[16:17], v[54:55] op_sel_hi:[1,0,1]
    v_lshlrev_b32 v18, 16, v206
    v_and_b32 v19, 0xffff0000, v206
    v_pk_fma_f32 v[56:57], v[18:19], v[16:17], v[56:57] op_sel_hi:[1,0,1]
    v_lshlrev_b32 v20, 16, v207
    v_and_b32 v21, 0xffff0000, v207
    v_pk_fma_f32 v[58:59], v[20:21], v[16:17], v[58:59] op_sel_hi:[1,0,1]
    ds_read_b128 v[184:187], v22 offset:18432
    ds_read_b128 v[188:191], v22 offset:19456
    ds_read_b128 v[192:195], v22 offset:20480
    ds_read_b128 v[196:199], v22 offset:21504
    ds_read_b128 v[200:203], v22 offset:22528
    ds_read_b128 v[204:207], v22 offset:23552
    s_waitcnt vmcnt(9)
    v_dot2_f32_bf16 v3, v88, v24, 0
    v_dot2_f32_bf16 v4, v94, v30, 0
    v_dot2_f32_bf16 v3, v89, v25, v3
    v_dot2_f32_bf16 v4, v95, v31, v4
    v_dot2_f32_bf16 v3, v90, v26, v3
    v_dot2_f32_bf16 v4, v96, v32, v4
    v_dot2_f32_bf16 v3, v91, v27, v3
    v_dot2_f32_bf16 v4, v97, v33, v4
    v_dot2_f32_bf16 v3, v92, v28, v3
    v_dot2_f32_bf16 v4, v98, v34, v4
    v_dot2_f32_bf16 v3, v93, v29, v3
    v_dot2_f32_bf16 v4, v99, v35, v4
    buffer_load_dwordx4 v[88:91], v1, s[32:35], s75 offen offset:0 nt
    buffer_load_dwordx4 v[92:95], v1, s[32:35], s75 offen offset:128 nt
    buffer_load_dwordx4 v[96:99], v1, s[32:35], s75 offen offset:256 nt
    v_add_f32 v3, v3, v4
    s_nop 1
    v_add_f32_dpp v3, v3, v3 quad_perm:[1,0,3,2] row_mask:0xf bank_mask:0xf
    s_nop 1
    v_add_f32_dpp v3, v3, v3 quad_perm:[2,3,0,1] row_mask:0xf bank_mask:0xf
    s_nop 1
    v_add_f32_dpp v3, v3, v3 row_half_mirror row_mask:0xf bank_mask:0xf
    v_cvt_pk_bf16_f32 v4, v3, v3
    v_lshlrev_b32 v4, 16, v4
    v_mul_f32 v4, 0x3d93cd3a, v4
    v_cvt_pk_bf16_f32 v4, v4, v4
    v_lshlrev_b32 v4, 16, v4
    v_max_f32 v5, v11, v4
    v_sub_f32 v6, v11, v5
    v_sub_f32 v7, v4, v5
    v_mul_f32 v6, 0x3fb8aa3b, v6
    v_mul_f32 v7, 0x3fb8aa3b, v7
    v_exp_f32 v14, v6
    v_exp_f32 v16, v7
    v_mov_b32 v11, v5
    v_fma_f32 v12, v12, v14, v16
    v_pk_mul_f32 v[36:37], v[36:37], v[14:15] op_sel_hi:[1,0]
    v_pk_mul_f32 v[38:39], v[38:39], v[14:15] op_sel_hi:[1,0]
    v_pk_mul_f32 v[40:41], v[40:41], v[14:15] op_sel_hi:[1,0]
    v_pk_mul_f32 v[42:43], v[42:43], v[14:15] op_sel_hi:[1,0]
    v_pk_mul_f32 v[44:45], v[44:45], v[14:15] op_sel_hi:[1,0]
    v_pk_mul_f32 v[46:47], v[46:47], v[14:15] op_sel_hi:[1,0]
    v_pk_mul_f32 v[48:49], v[48:49], v[14:15] op_sel_hi:[1,0]
    v_pk_mul_f32 v[50:51], v[50:51], v[14:15] op_sel_hi:[1,0]
    v_pk_mul_f32 v[52:53], v[52:53], v[14:15] op_sel_hi:[1,0]
    v_pk_mul_f32 v[54:55], v[54:55], v[14:15] op_sel_hi:[1,0]
    v_pk_mul_f32 v[56:57], v[56:57], v[14:15] op_sel_hi:[1,0]
    v_pk_mul_f32 v[58:59], v[58:59], v[14:15] op_sel_hi:[1,0]
    s_waitcnt vmcnt(9)
    v_lshlrev_b32 v18, 16, v100
    v_and_b32 v19, 0xffff0000, v100
    v_pk_fma_f32 v[36:37], v[18:19], v[16:17], v[36:37] op_sel_hi:[1,0,1]
    v_lshlrev_b32 v20, 16, v101
    v_and_b32 v21, 0xffff0000, v101
    v_pk_fma_f32 v[38:39], v[20:21], v[16:17], v[38:39] op_sel_hi:[1,0,1]
    v_lshlrev_b32 v18, 16, v102
    v_and_b32 v19, 0xffff0000, v102
    v_pk_fma_f32 v[40:41], v[18:19], v[16:17], v[40:41] op_sel_hi:[1,0,1]
    v_lshlrev_b32 v20, 16, v103
    v_and_b32 v21, 0xffff0000, v103
    v_pk_fma_f32 v[42:43], v[20:21], v[16:17], v[42:43] op_sel_hi:[1,0,1]
    v_lshlrev_b32 v18, 16, v104
    v_and_b32 v19, 0xffff0000, v104
    v_pk_fma_f32 v[44:45], v[18:19], v[16:17], v[44:45] op_sel_hi:[1,0,1]
    v_lshlrev_b32 v20, 16, v105
    v_and_b32 v21, 0xffff0000, v105
    v_pk_fma_f32 v[46:47], v[20:21], v[16:17], v[46:47] op_sel_hi:[1,0,1]
    v_lshlrev_b32 v18, 16, v106
    v_and_b32 v19, 0xffff0000, v106
    v_pk_fma_f32 v[48:49], v[18:19], v[16:17], v[48:49] op_sel_hi:[1,0,1]
    v_lshlrev_b32 v20, 16, v107
    v_and_b32 v21, 0xffff0000, v107
    v_pk_fma_f32 v[50:51], v[20:21], v[16:17], v[50:51] op_sel_hi:[1,0,1]
    v_lshlrev_b32 v18, 16, v108
    v_and_b32 v19, 0xffff0000, v108
    v_pk_fma_f32 v[52:53], v[18:19], v[16:17], v[52:53] op_sel_hi:[1,0,1]
    v_lshlrev_b32 v20, 16, v109
    v_and_b32 v21, 0xffff0000, v109
    v_pk_fma_f32 v[54:55], v[20:21], v[16:17], v[54:55] op_sel_hi:[1,0,1]
    v_lshlrev_b32 v18, 16, v110
    v_and_b32 v19, 0xffff0000, v110
    v_pk_fma_f32 v[56:57], v[18:19], v[16:17], v[56:57] op_sel_hi:[1,0,1]
    v_lshlrev_b32 v20, 16, v111
    v_and_b32 v21, 0xffff0000, v111
    v_pk_fma_f32 v[58:59], v[20:21], v[16:17], v[58:59] op_sel_hi:[1,0,1]
    buffer_load_dwordx4 v[100:103], v1, s[36:39], s75 offen offset:0 nt
    buffer_load_dwordx4 v[104:107], v1, s[36:39], s75 offen offset:128 nt
    buffer_load_dwordx4 v[108:111], v1, s[36:39], s75 offen offset:256 nt
    s_add_u32 s75, s75, 24576
    v_dot2_f32_bf16 v3, v208, v24, 0
    v_dot2_f32_bf16 v4, v214, v30, 0
    v_dot2_f32_bf16 v3, v209, v25, v3
    v_dot2_f32_bf16 v4, v215, v31, v4
    v_dot2_f32_bf16 v3, v210, v26, v3
    v_dot2_f32_bf16 v4, v216, v32, v4
    v_dot2_f32_bf16 v3, v211, v27, v3
    v_dot2_f32_bf16 v4, v217, v33, v4
    v_dot2_f32_bf16 v3, v212, v28, v3
    v_dot2_f32_bf16 v4, v218, v34, v4
    v_dot2_f32_bf16 v3, v213, v29, v3
    v_dot2_f32_bf16 v4, v219, v35, v4
    s_nop 2
    v_add_f32 v3, v3, v4
    s_nop 1
    v_add_f32_dpp v3, v3, v3 quad_perm:[1,0,3,2] row_mask:0xf bank_mask:0xf
    s_nop 1
    v_add_f32_dpp v3, v3, v3 quad_perm:[2,3,0,1] row_mask:0xf bank_mask:0xf
    s_nop 1
    v_add_f32_dpp v3, v3, v3 row_half_mirror row_mask:0xf bank_mask:0xf
    v_cvt_pk_bf16_f32 v4, v3, v3
    v_lshlrev_b32 v4, 16, v4
    v_mul_f32 v4, 0x3d93cd3a, v4
    v_cvt_pk_bf16_f32 v4, v4, v4
    v_lshlrev_b32 v4, 16, v4
    v_max_f32 v5, v11, v4
    v_sub_f32 v6, v11, v5
    v_sub_f32 v7, v4, v5
    v_mul_f32 v6, 0x3fb8aa3b, v6
    v_mul_f32 v7, 0x3fb8aa3b, v7
    v_exp_f32 v14, v6
    v_exp_f32 v16, v7
    v_mov_b32 v11, v5
    v_fma_f32 v12, v12, v14, v16
    v_pk_mul_f32 v[36:37], v[36:37], v[14:15] op_sel_hi:[1,0]
    v_pk_mul_f32 v[38:39], v[38:39], v[14:15] op_sel_hi:[1,0]
    v_pk_mul_f32 v[40:41], v[40:41], v[14:15] op_sel_hi:[1,0]
    v_pk_mul_f32 v[42:43], v[42:43], v[14:15] op_sel_hi:[1,0]
    v_pk_mul_f32 v[44:45], v[44:45], v[14:15] op_sel_hi:[1,0]
    v_pk_mul_f32 v[46:47], v[46:47], v[14:15] op_sel_hi:[1,0]
    v_pk_mul_f32 v[48:49], v[48:49], v[14:15] op_sel_hi:[1,0]
    v_pk_mul_f32 v[50:51], v[50:51], v[14:15] op_sel_hi:[1,0]
    v_pk_mul_f32 v[52:53], v[52:53], v[14:15] op_sel_hi:[1,0]
    v_pk_mul_f32 v[54:55], v[54:55], v[14:15] op_sel_hi:[1,0]
    v_pk_mul_f32 v[56:57], v[56:57], v[14:15] op_sel_hi:[1,0]
    v_pk_mul_f32 v[58:59], v[58:59], v[14:15] op_sel_hi:[1,0]
    v_lshlrev_b32 v18, 16, v220
    v_and_b32 v19, 0xffff0000, v220
    v_pk_fma_f32 v[36:37], v[18:19], v[16:17], v[36:37] op_sel_hi:[1,0,1]
    v_lshlrev_b32 v20, 16, v221
    v_and_b32 v21, 0xffff0000, v221
    v_pk_fma_f32 v[38:39], v[20:21], v[16:17], v[38:39] op_sel_hi:[1,0,1]
    v_lshlrev_b32 v18, 16, v222
    v_and_b32 v19, 0xffff0000, v222
    v_pk_fma_f32 v[40:41], v[18:19], v[16:17], v[40:41] op_sel_hi:[1,0,1]
    v_lshlrev_b32 v20, 16, v223
    v_and_b32 v21, 0xffff0000, v223
    v_pk_fma_f32 v[42:43], v[20:21], v[16:17], v[42:43] op_sel_hi:[1,0,1]
    v_lshlrev_b32 v18, 16, v224
    v_and_b32 v19, 0xffff0000, v224
    v_pk_fma_f32 v[44:45], v[18:19], v[16:17], v[44:45] op_sel_hi:[1,0,1]
    v_lshlrev_b32 v20, 16, v225
    v_and_b32 v21, 0xffff0000, v225
    v_pk_fma_f32 v[46:47], v[20:21], v[16:17], v[46:47] op_sel_hi:[1,0,1]
    v_lshlrev_b32 v18, 16, v226
    v_and_b32 v19, 0xffff0000, v226
    v_pk_fma_f32 v[48:49], v[18:19], v[16:17], v[48:49] op_sel_hi:[1,0,1]
    v_lshlrev_b32 v20, 16, v227
    v_and_b32 v21, 0xffff0000, v227
    v_pk_fma_f32 v[50:51], v[20:21], v[16:17], v[50:51] op_sel_hi:[1,0,1]
    v_lshlrev_b32 v18, 16, v228
    v_and_b32 v19, 0xffff0000, v228
    v_pk_fma_f32 v[52:53], v[18:19], v[16:17], v[52:53] op_sel_hi:[1,0,1]
    v_lshlrev_b32 v20, 16, v229
    v_and_b32 v21, 0xffff0000, v229
    v_pk_fma_f32 v[54:55], v[20:21], v[16:17], v[54:55] op_sel_hi:[1,0,1]
    v_lshlrev_b32 v18, 16, v230
    v_and_b32 v19, 0xffff0000, v230
    v_pk_fma_f32 v[56:57], v[18:19], v[16:17], v[56:57] op_sel_hi:[1,0,1]
    v_lshlrev_b32 v20, 16, v231
    v_and_b32 v21, 0xffff0000, v231
    v_pk_fma_f32 v[58:59], v[20:21], v[16:17], v[58:59] op_sel_hi:[1,0,1]
    ds_read_b128 v[208:211], v23 offset:0
    ds_read_b128 v[212:215], v23 offset:1024
    ds_read_b128 v[216:219], v23 offset:2048
    ds_read_b128 v[220:223], v23 offset:3072
    ds_read_b128 v[224:227], v23 offset:4096
    ds_read_b128 v[228:231], v23 offset:5120
    v_dot2_f32_bf16 v3, v232, v24, 0
    v_dot2_f32_bf16 v4, v238, v30, 0
    v_dot2_f32_bf16 v3, v233, v25, v3
    v_dot2_f32_bf16 v4, v239, v31, v4
    v_dot2_f32_bf16 v3, v234, v26, v3
    v_dot2_f32_bf16 v4, v240, v32, v4
    v_dot2_f32_bf16 v3, v235, v27, v3
    v_dot2_f32_bf16 v4, v241, v33, v4
    v_dot2_f32_bf16 v3, v236, v28, v3
    v_dot2_f32_bf16 v4, v242, v34, v4
    v_dot2_f32_bf16 v3, v237, v29, v3
    v_dot2_f32_bf16 v4, v243, v35, v4
    s_nop 2
    v_add_f32 v3, v3, v4
    s_nop 1
    v_add_f32_dpp v3, v3, v3 quad_perm:[1,0,3,2] row_mask:0xf bank_mask:0xf
    s_nop 1
    v_add_f32_dpp v3, v3, v3 quad_perm:[2,3,0,1] row_mask:0xf bank_mask:0xf
    s_nop 1
    v_add_f32_dpp v3, v3, v3 row_half_mirror row_mask:0xf bank_mask:0xf
    v_cvt_pk_bf16_f32 v4, v3, v3
    v_lshlrev_b32 v4, 16, v4
    v_mul_f32 v4, 0x3d93cd3a, v4
    v_cvt_pk_bf16_f32 v4, v4, v4
    v_lshlrev_b32 v4, 16, v4
    v_max_f32 v5, v11, v4
    v_sub_f32 v6, v11, v5
    v_sub_f32 v7, v4, v5
    v_mul_f32 v6, 0x3fb8aa3b, v6
    v_mul_f32 v7, 0x3fb8aa3b, v7
    v_exp_f32 v14, v6
    v_exp_f32 v16, v7
    v_mov_b32 v11, v5
    v_fma_f32 v12, v12, v14, v16
    v_pk_mul_f32 v[36:37], v[36:37], v[14:15] op_sel_hi:[1,0]
    v_pk_mul_f32 v[38:39], v[38:39], v[14:15] op_sel_hi:[1,0]
    v_pk_mul_f32 v[40:41], v[40:41], v[14:15] op_sel_hi:[1,0]
    v_pk_mul_f32 v[42:43], v[42:43], v[14:15] op_sel_hi:[1,0]
    v_pk_mul_f32 v[44:45], v[44:45], v[14:15] op_sel_hi:[1,0]
    v_pk_mul_f32 v[46:47], v[46:47], v[14:15] op_sel_hi:[1,0]
    v_pk_mul_f32 v[48:49], v[48:49], v[14:15] op_sel_hi:[1,0]
    v_pk_mul_f32 v[50:51], v[50:51], v[14:15] op_sel_hi:[1,0]
    v_pk_mul_f32 v[52:53], v[52:53], v[14:15] op_sel_hi:[1,0]
    v_pk_mul_f32 v[54:55], v[54:55], v[14:15] op_sel_hi:[1,0]
    v_pk_mul_f32 v[56:57], v[56:57], v[14:15] op_sel_hi:[1,0]
    v_pk_mul_f32 v[58:59], v[58:59], v[14:15] op_sel_hi:[1,0]
    v_lshlrev_b32 v18, 16, v244
    v_and_b32 v19, 0xffff0000, v244
    v_pk_fma_f32 v[36:37], v[18:19], v[16:17], v[36:37] op_sel_hi:[1,0,1]
    v_lshlrev_b32 v20, 16, v245
    v_and_b32 v21, 0xffff0000, v245
    v_pk_fma_f32 v[38:39], v[20:21], v[16:17], v[38:39] op_sel_hi:[1,0,1]
    v_lshlrev_b32 v18, 16, v246
    v_and_b32 v19, 0xffff0000, v246
    v_pk_fma_f32 v[40:41], v[18:19], v[16:17], v[40:41] op_sel_hi:[1,0,1]
    v_lshlrev_b32 v20, 16, v247
    v_and_b32 v21, 0xffff0000, v247
    v_pk_fma_f32 v[42:43], v[20:21], v[16:17], v[42:43] op_sel_hi:[1,0,1]
    v_lshlrev_b32 v18, 16, v248
    v_and_b32 v19, 0xffff0000, v248
    v_pk_fma_f32 v[44:45], v[18:19], v[16:17], v[44:45] op_sel_hi:[1,0,1]
    v_lshlrev_b32 v20, 16, v249
    v_and_b32 v21, 0xffff0000, v249
    v_pk_fma_f32 v[46:47], v[20:21], v[16:17], v[46:47] op_sel_hi:[1,0,1]
    v_lshlrev_b32 v18, 16, v250
    v_and_b32 v19, 0xffff0000, v250
    v_pk_fma_f32 v[48:49], v[18:19], v[16:17], v[48:49] op_sel_hi:[1,0,1]
    v_lshlrev_b32 v20, 16, v251
    v_and_b32 v21, 0xffff0000, v251
    v_pk_fma_f32 v[50:51], v[20:21], v[16:17], v[50:51] op_sel_hi:[1,0,1]
    v_lshlrev_b32 v18, 16, v252
    v_and_b32 v19, 0xffff0000, v252
    v_pk_fma_f32 v[52:53], v[18:19], v[16:17], v[52:53] op_sel_hi:[1,0,1]
    v_lshlrev_b32 v20, 16, v253
    v_and_b32 v21, 0xffff0000, v253
    v_pk_fma_f32 v[54:55], v[20:21], v[16:17], v[54:55] op_sel_hi:[1,0,1]
    v_lshlrev_b32 v18, 16, v254
    v_and_b32 v19, 0xffff0000, v254
    v_pk_fma_f32 v[56:57], v[18:19], v[16:17], v[56:57] op_sel_hi:[1,0,1]
    v_lshlrev_b32 v20, 16, v255
    v_and_b32 v21, 0xffff0000, v255
    v_pk_fma_f32 v[58:59], v[20:21], v[16:17], v[58:59] op_sel_hi:[1,0,1]
    ds_read_b128 v[232:235], v23 offset:6144
    ds_read_b128 v[236:239], v23 offset:7168
    ds_read_b128 v[240:243], v23 offset:8192
    ds_read_b128 v[244:247], v23 offset:9216
    ds_read_b128 v[248:251], v23 offset:10240
    ds_read_b128 v[252:255], v23 offset:11264
    s_waitcnt vmcnt(9)
    v_dot2_f32_bf16 v3, v64, v24, 0
    v_dot2_f32_bf16 v4, v70, v30, 0
    v_dot2_f32_bf16 v3, v65, v25, v3
    v_dot2_f32_bf16 v4, v71, v31, v4
    v_dot2_f32_bf16 v3, v66, v26, v3
    v_dot2_f32_bf16 v4, v72, v32, v4
    v_dot2_f32_bf16 v3, v67, v27, v3
    v_dot2_f32_bf16 v4, v73, v33, v4
    v_dot2_f32_bf16 v3, v68, v28, v3
    v_dot2_f32_bf16 v4, v74, v34, v4
    v_dot2_f32_bf16 v3, v69, v29, v3
    v_dot2_f32_bf16 v4, v75, v35, v4
    buffer_load_dwordx4 v[64:67], v1, s[32:35], s75 offen offset:0 nt
    buffer_load_dwordx4 v[68:71], v1, s[32:35], s75 offen offset:128 nt
    buffer_load_dwordx4 v[72:75], v1, s[32:35], s75 offen offset:256 nt
    v_add_f32 v3, v3, v4
    s_nop 1
    v_add_f32_dpp v3, v3, v3 quad_perm:[1,0,3,2] row_mask:0xf bank_mask:0xf
    s_nop 1
    v_add_f32_dpp v3, v3, v3 quad_perm:[2,3,0,1] row_mask:0xf bank_mask:0xf
    s_nop 1
    v_add_f32_dpp v3, v3, v3 row_half_mirror row_mask:0xf bank_mask:0xf
    v_cvt_pk_bf16_f32 v4, v3, v3
    v_lshlrev_b32 v4, 16, v4
    v_mul_f32 v4, 0x3d93cd3a, v4
    v_cvt_pk_bf16_f32 v4, v4, v4
    v_lshlrev_b32 v4, 16, v4
    v_max_f32 v5, v11, v4
    v_sub_f32 v6, v11, v5
    v_sub_f32 v7, v4, v5
    v_mul_f32 v6, 0x3fb8aa3b, v6
    v_mul_f32 v7, 0x3fb8aa3b, v7
    v_exp_f32 v14, v6
    v_exp_f32 v16, v7
    v_mov_b32 v11, v5
    v_fma_f32 v12, v12, v14, v16
    v_pk_mul_f32 v[36:37], v[36:37], v[14:15] op_sel_hi:[1,0]
    v_pk_mul_f32 v[38:39], v[38:39], v[14:15] op_sel_hi:[1,0]
    v_pk_mul_f32 v[40:41], v[40:41], v[14:15] op_sel_hi:[1,0]
    v_pk_mul_f32 v[42:43], v[42:43], v[14:15] op_sel_hi:[1,0]
    v_pk_mul_f32 v[44:45], v[44:45], v[14:15] op_sel_hi:[1,0]
    v_pk_mul_f32 v[46:47], v[46:47], v[14:15] op_sel_hi:[1,0]
    v_pk_mul_f32 v[48:49], v[48:49], v[14:15] op_sel_hi:[1,0]
    v_pk_mul_f32 v[50:51], v[50:51], v[14:15] op_sel_hi:[1,0]
    v_pk_mul_f32 v[52:53], v[52:53], v[14:15] op_sel_hi:[1,0]
    v_pk_mul_f32 v[54:55], v[54:55], v[14:15] op_sel_hi:[1,0]
    v_pk_mul_f32 v[56:57], v[56:57], v[14:15] op_sel_hi:[1,0]
    v_pk_mul_f32 v[58:59], v[58:59], v[14:15] op_sel_hi:[1,0]
    s_waitcnt vmcnt(9)
    v_lshlrev_b32 v18, 16, v76
    v_and_b32 v19, 0xffff0000, v76
    v_pk_fma_f32 v[36:37], v[18:19], v[16:17], v[36:37] op_sel_hi:[1,0,1]
    v_lshlrev_b32 v20, 16, v77
    v_and_b32 v21, 0xffff0000, v77
    v_pk_fma_f32 v[38:39], v[20:21], v[16:17], v[38:39] op_sel_hi:[1,0,1]
    v_lshlrev_b32 v18, 16, v78
    v_and_b32 v19, 0xffff0000, v78
    v_pk_fma_f32 v[40:41], v[18:19], v[16:17], v[40:41] op_sel_hi:[1,0,1]
    v_lshlrev_b32 v20, 16, v79
    v_and_b32 v21, 0xffff0000, v79
    v_pk_fma_f32 v[42:43], v[20:21], v[16:17], v[42:43] op_sel_hi:[1,0,1]
    v_lshlrev_b32 v18, 16, v80
    v_and_b32 v19, 0xffff0000, v80
    v_pk_fma_f32 v[44:45], v[18:19], v[16:17], v[44:45] op_sel_hi:[1,0,1]
    v_lshlrev_b32 v20, 16, v81
    v_and_b32 v21, 0xffff0000, v81
    v_pk_fma_f32 v[46:47], v[20:21], v[16:17], v[46:47] op_sel_hi:[1,0,1]
    v_lshlrev_b32 v18, 16, v82
    v_and_b32 v19, 0xffff0000, v82
    v_pk_fma_f32 v[48:49], v[18:19], v[16:17], v[48:49] op_sel_hi:[1,0,1]
    v_lshlrev_b32 v20, 16, v83
    v_and_b32 v21, 0xffff0000, v83
    v_pk_fma_f32 v[50:51], v[20:21], v[16:17], v[50:51] op_sel_hi:[1,0,1]
    v_lshlrev_b32 v18, 16, v84
    v_and_b32 v19, 0xffff0000, v84
    v_pk_fma_f32 v[52:53], v[18:19], v[16:17], v[52:53] op_sel_hi:[1,0,1]
    v_lshlrev_b32 v20, 16, v85
    v_and_b32 v21, 0xffff0000, v85
    v_pk_fma_f32 v[54:55], v[20:21], v[16:17], v[54:55] op_sel_hi:[1,0,1]
    v_lshlrev_b32 v18, 16, v86
    v_and_b32 v19, 0xffff0000, v86
    v_pk_fma_f32 v[56:57], v[18:19], v[16:17], v[56:57] op_sel_hi:[1,0,1]
    v_lshlrev_b32 v20, 16, v87
    v_and_b32 v21, 0xffff0000, v87
    v_pk_fma_f32 v[58:59], v[20:21], v[16:17], v[58:59] op_sel_hi:[1,0,1]
    buffer_load_dwordx4 v[76:79], v1, s[36:39], s75 offen offset:0 nt
    buffer_load_dwordx4 v[80:83], v1, s[36:39], s75 offen offset:128 nt
    buffer_load_dwordx4 v[84:87], v1, s[36:39], s75 offen offset:256 nt
    s_add_u32 s75, s75, 24576
    s_waitcnt lgkmcnt(0)
    v_dot2_f32_bf16 v3, v112, v24, 0
    v_dot2_f32_bf16 v4, v118, v30, 0
    v_dot2_f32_bf16 v3, v113, v25, v3
    v_dot2_f32_bf16 v4, v119, v31, v4
    v_dot2_f32_bf16 v3, v114, v26, v3
    v_dot2_f32_bf16 v4, v120, v32, v4
    v_dot2_f32_bf16 v3, v115, v27, v3
    v_dot2_f32_bf16 v4, v121, v33, v4
    v_dot2_f32_bf16 v3, v116, v28, v3
    v_dot2_f32_bf16 v4, v122, v34, v4
    v_dot2_f32_bf16 v3, v117, v29, v3
    v_dot2_f32_bf16 v4, v123, v35, v4
    s_nop 2
    v_add_f32 v3, v3, v4
    s_nop 1
    v_add_f32_dpp v3, v3, v3 quad_perm:[1,0,3,2] row_mask:0xf bank_mask:0xf
    s_nop 1
    v_add_f32_dpp v3, v3, v3 quad_perm:[2,3,0,1] row_mask:0xf bank_mask:0xf
    s_nop 1
    v_add_f32_dpp v3, v3, v3 row_half_mirror row_mask:0xf bank_mask:0xf
    v_cvt_pk_bf16_f32 v4, v3, v3
    v_lshlrev_b32 v4, 16, v4
    v_mul_f32 v4, 0x3d93cd3a, v4
    v_cvt_pk_bf16_f32 v4, v4, v4
    v_lshlrev_b32 v4, 16, v4
    v_max_f32 v5, v11, v4
    v_sub_f32 v6, v11, v5
    v_sub_f32 v7, v4, v5
    v_mul_f32 v6, 0x3fb8aa3b, v6
    v_mul_f32 v7, 0x3fb8aa3b, v7
    v_exp_f32 v14, v6
    v_exp_f32 v16, v7
    v_mov_b32 v11, v5
    v_fma_f32 v12, v12, v14, v16
    v_pk_mul_f32 v[36:37], v[36:37], v[14:15] op_sel_hi:[1,0]
    v_pk_mul_f32 v[38:39], v[38:39], v[14:15] op_sel_hi:[1,0]
    v_pk_mul_f32 v[40:41], v[40:41], v[14:15] op_sel_hi:[1,0]
    v_pk_mul_f32 v[42:43], v[42:43], v[14:15] op_sel_hi:[1,0]
    v_pk_mul_f32 v[44:45], v[44:45], v[14:15] op_sel_hi:[1,0]
    v_pk_mul_f32 v[46:47], v[46:47], v[14:15] op_sel_hi:[1,0]
    v_pk_mul_f32 v[48:49], v[48:49], v[14:15] op_sel_hi:[1,0]
    v_pk_mul_f32 v[50:51], v[50:51], v[14:15] op_sel_hi:[1,0]
    v_pk_mul_f32 v[52:53], v[52:53], v[14:15] op_sel_hi:[1,0]
    v_pk_mul_f32 v[54:55], v[54:55], v[14:15] op_sel_hi:[1,0]
    v_pk_mul_f32 v[56:57], v[56:57], v[14:15] op_sel_hi:[1,0]
    v_pk_mul_f32 v[58:59], v[58:59], v[14:15] op_sel_hi:[1,0]
    v_lshlrev_b32 v18, 16, v124
    v_and_b32 v19, 0xffff0000, v124
    v_pk_fma_f32 v[36:37], v[18:19], v[16:17], v[36:37] op_sel_hi:[1,0,1]
    v_lshlrev_b32 v20, 16, v125
    v_and_b32 v21, 0xffff0000, v125
    v_pk_fma_f32 v[38:39], v[20:21], v[16:17], v[38:39] op_sel_hi:[1,0,1]
    v_lshlrev_b32 v18, 16, v126
    v_and_b32 v19, 0xffff0000, v126
    v_pk_fma_f32 v[40:41], v[18:19], v[16:17], v[40:41] op_sel_hi:[1,0,1]
    v_lshlrev_b32 v20, 16, v127
    v_and_b32 v21, 0xffff0000, v127
    v_pk_fma_f32 v[42:43], v[20:21], v[16:17], v[42:43] op_sel_hi:[1,0,1]
    v_lshlrev_b32 v18, 16, v128
    v_and_b32 v19, 0xffff0000, v128
    v_pk_fma_f32 v[44:45], v[18:19], v[16:17], v[44:45] op_sel_hi:[1,0,1]
    v_lshlrev_b32 v20, 16, v129
    v_and_b32 v21, 0xffff0000, v129
    v_pk_fma_f32 v[46:47], v[20:21], v[16:17], v[46:47] op_sel_hi:[1,0,1]
    v_lshlrev_b32 v18, 16, v130
    v_and_b32 v19, 0xffff0000, v130
    v_pk_fma_f32 v[48:49], v[18:19], v[16:17], v[48:49] op_sel_hi:[1,0,1]
    v_lshlrev_b32 v20, 16, v131
    v_and_b32 v21, 0xffff0000, v131
    v_pk_fma_f32 v[50:51], v[20:21], v[16:17], v[50:51] op_sel_hi:[1,0,1]
    v_lshlrev_b32 v18, 16, v132
    v_and_b32 v19, 0xffff0000, v132
    v_pk_fma_f32 v[52:53], v[18:19], v[16:17], v[52:53] op_sel_hi:[1,0,1]
    v_lshlrev_b32 v20, 16, v133
    v_and_b32 v21, 0xffff0000, v133
    v_pk_fma_f32 v[54:55], v[20:21], v[16:17], v[54:55] op_sel_hi:[1,0,1]
    v_lshlrev_b32 v18, 16, v134
    v_and_b32 v19, 0xffff0000, v134
    v_pk_fma_f32 v[56:57], v[18:19], v[16:17], v[56:57] op_sel_hi:[1,0,1]
    v_lshlrev_b32 v20, 16, v135
    v_and_b32 v21, 0xffff0000, v135
    v_pk_fma_f32 v[58:59], v[20:21], v[16:17], v[58:59] op_sel_hi:[1,0,1]
    s_waitcnt vmcnt(9)
    v_dot2_f32_bf16 v3, v88, v24, 0
    v_dot2_f32_bf16 v4, v94, v30, 0
    v_dot2_f32_bf16 v3, v89, v25, v3
    v_dot2_f32_bf16 v4, v95, v31, v4
    v_dot2_f32_bf16 v3, v90, v26, v3
    v_dot2_f32_bf16 v4, v96, v32, v4
    v_dot2_f32_bf16 v3, v91, v27, v3
    v_dot2_f32_bf16 v4, v97, v33, v4
    v_dot2_f32_bf16 v3, v92, v28, v3
    v_dot2_f32_bf16 v4, v98, v34, v4
    v_dot2_f32_bf16 v3, v93, v29, v3
    v_dot2_f32_bf16 v4, v99, v35, v4
    buffer_load_dwordx4 v[88:91], v1, s[32:35], s75 offen offset:0 nt
    buffer_load_dwordx4 v[92:95], v1, s[32:35], s75 offen offset:128 nt
    buffer_load_dwordx4 v[96:99], v1, s[32:35], s75 offen offset:256 nt
    v_add_f32 v3, v3, v4
    s_nop 1
    v_add_f32_dpp v3, v3, v3 quad_perm:[1,0,3,2] row_mask:0xf bank_mask:0xf
    s_nop 1
    v_add_f32_dpp v3, v3, v3 quad_perm:[2,3,0,1] row_mask:0xf bank_mask:0xf
    s_nop 1
    v_add_f32_dpp v3, v3, v3 row_half_mirror row_mask:0xf bank_mask:0xf
    v_cvt_pk_bf16_f32 v4, v3, v3
    v_lshlrev_b32 v4, 16, v4
    v_mul_f32 v4, 0x3d93cd3a, v4
    v_cvt_pk_bf16_f32 v4, v4, v4
    v_lshlrev_b32 v4, 16, v4
    v_max_f32 v5, v11, v4
    v_sub_f32 v6, v11, v5
    v_sub_f32 v7, v4, v5
    v_mul_f32 v6, 0x3fb8aa3b, v6
    v_mul_f32 v7, 0x3fb8aa3b, v7
    v_exp_f32 v14, v6
    v_exp_f32 v16, v7
    v_mov_b32 v11, v5
    v_fma_f32 v12, v12, v14, v16
    v_pk_mul_f32 v[36:37], v[36:37], v[14:15] op_sel_hi:[1,0]
    v_pk_mul_f32 v[38:39], v[38:39], v[14:15] op_sel_hi:[1,0]
    v_pk_mul_f32 v[40:41], v[40:41], v[14:15] op_sel_hi:[1,0]
    v_pk_mul_f32 v[42:43], v[42:43], v[14:15] op_sel_hi:[1,0]
    v_pk_mul_f32 v[44:45], v[44:45], v[14:15] op_sel_hi:[1,0]
    v_pk_mul_f32 v[46:47], v[46:47], v[14:15] op_sel_hi:[1,0]
    v_pk_mul_f32 v[48:49], v[48:49], v[14:15] op_sel_hi:[1,0]
    v_pk_mul_f32 v[50:51], v[50:51], v[14:15] op_sel_hi:[1,0]
    v_pk_mul_f32 v[52:53], v[52:53], v[14:15] op_sel_hi:[1,0]
    v_pk_mul_f32 v[54:55], v[54:55], v[14:15] op_sel_hi:[1,0]
    v_pk_mul_f32 v[56:57], v[56:57], v[14:15] op_sel_hi:[1,0]
    v_pk_mul_f32 v[58:59], v[58:59], v[14:15] op_sel_hi:[1,0]
    s_waitcnt vmcnt(9)
    v_lshlrev_b32 v18, 16, v100
    v_and_b32 v19, 0xffff0000, v100
    v_pk_fma_f32 v[36:37], v[18:19], v[16:17], v[36:37] op_sel_hi:[1,0,1]
    v_lshlrev_b32 v20, 16, v101
    v_and_b32 v21, 0xffff0000, v101
    v_pk_fma_f32 v[38:39], v[20:21], v[16:17], v[38:39] op_sel_hi:[1,0,1]
    v_lshlrev_b32 v18, 16, v102
    v_and_b32 v19, 0xffff0000, v102
    v_pk_fma_f32 v[40:41], v[18:19], v[16:17], v[40:41] op_sel_hi:[1,0,1]
    v_lshlrev_b32 v20, 16, v103
    v_and_b32 v21, 0xffff0000, v103
    v_pk_fma_f32 v[42:43], v[20:21], v[16:17], v[42:43] op_sel_hi:[1,0,1]
    v_lshlrev_b32 v18, 16, v104
    v_and_b32 v19, 0xffff0000, v104
    v_pk_fma_f32 v[44:45], v[18:19], v[16:17], v[44:45] op_sel_hi:[1,0,1]
    v_lshlrev_b32 v20, 16, v105
    v_and_b32 v21, 0xffff0000, v105
    v_pk_fma_f32 v[46:47], v[20:21], v[16:17], v[46:47] op_sel_hi:[1,0,1]
    v_lshlrev_b32 v18, 16, v106
    v_and_b32 v19, 0xffff0000, v106
    v_pk_fma_f32 v[48:49], v[18:19], v[16:17], v[48:49] op_sel_hi:[1,0,1]
    v_lshlrev_b32 v20, 16, v107
    v_and_b32 v21, 0xffff0000, v107
    v_pk_fma_f32 v[50:51], v[20:21], v[16:17], v[50:51] op_sel_hi:[1,0,1]
    v_lshlrev_b32 v18, 16, v108
    v_and_b32 v19, 0xffff0000, v108
    v_pk_fma_f32 v[52:53], v[18:19], v[16:17], v[52:53] op_sel_hi:[1,0,1]
    v_lshlrev_b32 v20, 16, v109
    v_and_b32 v21, 0xffff0000, v109
    v_pk_fma_f32 v[54:55], v[20:21], v[16:17], v[54:55] op_sel_hi:[1,0,1]
    v_lshlrev_b32 v18, 16, v110
    v_and_b32 v19, 0xffff0000, v110
    v_pk_fma_f32 v[56:57], v[18:19], v[16:17], v[56:57] op_sel_hi:[1,0,1]
    v_lshlrev_b32 v20, 16, v111
    v_and_b32 v21, 0xffff0000, v111
    v_pk_fma_f32 v[58:59], v[20:21], v[16:17], v[58:59] op_sel_hi:[1,0,1]
    buffer_load_dwordx4 v[100:103], v1, s[36:39], s75 offen offset:0 nt
    buffer_load_dwordx4 v[104:107], v1, s[36:39], s75 offen offset:128 nt
    buffer_load_dwordx4 v[108:111], v1, s[36:39], s75 offen offset:256 nt
    s_add_u32 s75, s75, 24576
    s_waitcnt lgkmcnt(0)
    v_dot2_f32_bf16 v3, v136, v24, 0
    v_dot2_f32_bf16 v4, v142, v30, 0
    v_dot2_f32_bf16 v3, v137, v25, v3
    v_dot2_f32_bf16 v4, v143, v31, v4
    v_dot2_f32_bf16 v3, v138, v26, v3
    v_dot2_f32_bf16 v4, v144, v32, v4
    v_dot2_f32_bf16 v3, v139, v27, v3
    v_dot2_f32_bf16 v4, v145, v33, v4
    v_dot2_f32_bf16 v3, v140, v28, v3
    v_dot2_f32_bf16 v4, v146, v34, v4
    v_dot2_f32_bf16 v3, v141, v29, v3
    v_dot2_f32_bf16 v4, v147, v35, v4
    s_nop 2
    v_add_f32 v3, v3, v4
    s_nop 1
    v_add_f32_dpp v3, v3, v3 quad_perm:[1,0,3,2] row_mask:0xf bank_mask:0xf
    s_nop 1
    v_add_f32_dpp v3, v3, v3 quad_perm:[2,3,0,1] row_mask:0xf bank_mask:0xf
    s_nop 1
    v_add_f32_dpp v3, v3, v3 row_half_mirror row_mask:0xf bank_mask:0xf
    v_cvt_pk_bf16_f32 v4, v3, v3
    v_lshlrev_b32 v4, 16, v4
    v_mul_f32 v4, 0x3d93cd3a, v4
    v_cvt_pk_bf16_f32 v4, v4, v4
    v_lshlrev_b32 v4, 16, v4
    v_max_f32 v5, v11, v4
    v_sub_f32 v6, v11, v5
    v_sub_f32 v7, v4, v5
    v_mul_f32 v6, 0x3fb8aa3b, v6
    v_mul_f32 v7, 0x3fb8aa3b, v7
    v_exp_f32 v14, v6
    v_exp_f32 v16, v7
    v_mov_b32 v11, v5
    v_fma_f32 v12, v12, v14, v16
    v_pk_mul_f32 v[36:37], v[36:37], v[14:15] op_sel_hi:[1,0]
    v_pk_mul_f32 v[38:39], v[38:39], v[14:15] op_sel_hi:[1,0]
    v_pk_mul_f32 v[40:41], v[40:41], v[14:15] op_sel_hi:[1,0]
    v_pk_mul_f32 v[42:43], v[42:43], v[14:15] op_sel_hi:[1,0]
    v_pk_mul_f32 v[44:45], v[44:45], v[14:15] op_sel_hi:[1,0]
    v_pk_mul_f32 v[46:47], v[46:47], v[14:15] op_sel_hi:[1,0]
    v_pk_mul_f32 v[48:49], v[48:49], v[14:15] op_sel_hi:[1,0]
    v_pk_mul_f32 v[50:51], v[50:51], v[14:15] op_sel_hi:[1,0]
    v_pk_mul_f32 v[52:53], v[52:53], v[14:15] op_sel_hi:[1,0]
    v_pk_mul_f32 v[54:55], v[54:55], v[14:15] op_sel_hi:[1,0]
    v_pk_mul_f32 v[56:57], v[56:57], v[14:15] op_sel_hi:[1,0]
    v_pk_mul_f32 v[58:59], v[58:59], v[14:15] op_sel_hi:[1,0]
    v_lshlrev_b32 v18, 16, v148
    v_and_b32 v19, 0xffff0000, v148
    v_pk_fma_f32 v[36:37], v[18:19], v[16:17], v[36:37] op_sel_hi:[1,0,1]
    v_lshlrev_b32 v20, 16, v149
    v_and_b32 v21, 0xffff0000, v149
    v_pk_fma_f32 v[38:39], v[20:21], v[16:17], v[38:39] op_sel_hi:[1,0,1]
    v_lshlrev_b32 v18, 16, v150
    v_and_b32 v19, 0xffff0000, v150
    v_pk_fma_f32 v[40:41], v[18:19], v[16:17], v[40:41] op_sel_hi:[1,0,1]
    v_lshlrev_b32 v20, 16, v151
    v_and_b32 v21, 0xffff0000, v151
    v_pk_fma_f32 v[42:43], v[20:21], v[16:17], v[42:43] op_sel_hi:[1,0,1]
    v_lshlrev_b32 v18, 16, v152
    v_and_b32 v19, 0xffff0000, v152
    v_pk_fma_f32 v[44:45], v[18:19], v[16:17], v[44:45] op_sel_hi:[1,0,1]
    v_lshlrev_b32 v20, 16, v153
    v_and_b32 v21, 0xffff0000, v153
    v_pk_fma_f32 v[46:47], v[20:21], v[16:17], v[46:47] op_sel_hi:[1,0,1]
    v_lshlrev_b32 v18, 16, v154
    v_and_b32 v19, 0xffff0000, v154
    v_pk_fma_f32 v[48:49], v[18:19], v[16:17], v[48:49] op_sel_hi:[1,0,1]
    v_lshlrev_b32 v20, 16, v155
    v_and_b32 v21, 0xffff0000, v155
    v_pk_fma_f32 v[50:51], v[20:21], v[16:17], v[50:51] op_sel_hi:[1,0,1]
    v_lshlrev_b32 v18, 16, v156
    v_and_b32 v19, 0xffff0000, v156
    v_pk_fma_f32 v[52:53], v[18:19], v[16:17], v[52:53] op_sel_hi:[1,0,1]
    v_lshlrev_b32 v20, 16, v157
    v_and_b32 v21, 0xffff0000, v157
    v_pk_fma_f32 v[54:55], v[20:21], v[16:17], v[54:55] op_sel_hi:[1,0,1]
    v_lshlrev_b32 v18, 16, v158
    v_and_b32 v19, 0xffff0000, v158
    v_pk_fma_f32 v[56:57], v[18:19], v[16:17], v[56:57] op_sel_hi:[1,0,1]
    v_lshlrev_b32 v20, 16, v159
    v_and_b32 v21, 0xffff0000, v159
    v_pk_fma_f32 v[58:59], v[20:21], v[16:17], v[58:59] op_sel_hi:[1,0,1]
    s_waitcnt lgkmcnt(0)
    v_dot2_f32_bf16 v3, v160, v24, 0
    v_dot2_f32_bf16 v4, v166, v30, 0
    v_dot2_f32_bf16 v3, v161, v25, v3
    v_dot2_f32_bf16 v4, v167, v31, v4
    v_dot2_f32_bf16 v3, v162, v26, v3
    v_dot2_f32_bf16 v4, v168, v32, v4
    v_dot2_f32_bf16 v3, v163, v27, v3
    v_dot2_f32_bf16 v4, v169, v33, v4
    v_dot2_f32_bf16 v3, v164, v28, v3
    v_dot2_f32_bf16 v4, v170, v34, v4
    v_dot2_f32_bf16 v3, v165, v29, v3
    v_dot2_f32_bf16 v4, v171, v35, v4
    s_nop 2
    v_add_f32 v3, v3, v4
    s_nop 1
    v_add_f32_dpp v3, v3, v3 quad_perm:[1,0,3,2] row_mask:0xf bank_mask:0xf
    s_nop 1
    v_add_f32_dpp v3, v3, v3 quad_perm:[2,3,0,1] row_mask:0xf bank_mask:0xf
    s_nop 1
    v_add_f32_dpp v3, v3, v3 row_half_mirror row_mask:0xf bank_mask:0xf
    v_cvt_pk_bf16_f32 v4, v3, v3
    v_lshlrev_b32 v4, 16, v4
    v_mul_f32 v4, 0x3d93cd3a, v4
    v_cvt_pk_bf16_f32 v4, v4, v4
    v_lshlrev_b32 v4, 16, v4
    v_max_f32 v5, v11, v4
    v_sub_f32 v6, v11, v5
    v_sub_f32 v7, v4, v5
    v_mul_f32 v6, 0x3fb8aa3b, v6
    v_mul_f32 v7, 0x3fb8aa3b, v7
    v_exp_f32 v14, v6
    v_exp_f32 v16, v7
    v_mov_b32 v11, v5
    v_fma_f32 v12, v12, v14, v16
    v_pk_mul_f32 v[36:37], v[36:37], v[14:15] op_sel_hi:[1,0]
    v_pk_mul_f32 v[38:39], v[38:39], v[14:15] op_sel_hi:[1,0]
    v_pk_mul_f32 v[40:41], v[40:41], v[14:15] op_sel_hi:[1,0]
    v_pk_mul_f32 v[42:43], v[42:43], v[14:15] op_sel_hi:[1,0]
    v_pk_mul_f32 v[44:45], v[44:45], v[14:15] op_sel_hi:[1,0]
    v_pk_mul_f32 v[46:47], v[46:47], v[14:15] op_sel_hi:[1,0]
    v_pk_mul_f32 v[48:49], v[48:49], v[14:15] op_sel_hi:[1,0]
    v_pk_mul_f32 v[50:51], v[50:51], v[14:15] op_sel_hi:[1,0]
    v_pk_mul_f32 v[52:53], v[52:53], v[14:15] op_sel_hi:[1,0]
    v_pk_mul_f32 v[54:55], v[54:55], v[14:15] op_sel_hi:[1,0]
    v_pk_mul_f32 v[56:57], v[56:57], v[14:15] op_sel_hi:[1,0]
    v_pk_mul_f32 v[58:59], v[58:59], v[14:15] op_sel_hi:[1,0]
    v_lshlrev_b32 v18, 16, v172
    v_and_b32 v19, 0xffff0000, v172
    v_pk_fma_f32 v[36:37], v[18:19], v[16:17], v[36:37] op_sel_hi:[1,0,1]
    v_lshlrev_b32 v20, 16, v173
    v_and_b32 v21, 0xffff0000, v173
    v_pk_fma_f32 v[38:39], v[20:21], v[16:17], v[38:39] op_sel_hi:[1,0,1]
    v_lshlrev_b32 v18, 16, v174
    v_and_b32 v19, 0xffff0000, v174
    v_pk_fma_f32 v[40:41], v[18:19], v[16:17], v[40:41] op_sel_hi:[1,0,1]
    v_lshlrev_b32 v20, 16, v175
    v_and_b32 v21, 0xffff0000, v175
    v_pk_fma_f32 v[42:43], v[20:21], v[16:17], v[42:43] op_sel_hi:[1,0,1]
    v_lshlrev_b32 v18, 16, v176
    v_and_b32 v19, 0xffff0000, v176
    v_pk_fma_f32 v[44:45], v[18:19], v[16:17], v[44:45] op_sel_hi:[1,0,1]
    v_lshlrev_b32 v20, 16, v177
    v_and_b32 v21, 0xffff0000, v177
    v_pk_fma_f32 v[46:47], v[20:21], v[16:17], v[46:47] op_sel_hi:[1,0,1]
    v_lshlrev_b32 v18, 16, v178
    v_and_b32 v19, 0xffff0000, v178
    v_pk_fma_f32 v[48:49], v[18:19], v[16:17], v[48:49] op_sel_hi:[1,0,1]
    v_lshlrev_b32 v20, 16, v179
    v_and_b32 v21, 0xffff0000, v179
    v_pk_fma_f32 v[50:51], v[20:21], v[16:17], v[50:51] op_sel_hi:[1,0,1]
    v_lshlrev_b32 v18, 16, v180
    v_and_b32 v19, 0xffff0000, v180
    v_pk_fma_f32 v[52:53], v[18:19], v[16:17], v[52:53] op_sel_hi:[1,0,1]
    v_lshlrev_b32 v20, 16, v181
    v_and_b32 v21, 0xffff0000, v181
    v_pk_fma_f32 v[54:55], v[20:21], v[16:17], v[54:55] op_sel_hi:[1,0,1]
    v_lshlrev_b32 v18, 16, v182
    v_and_b32 v19, 0xffff0000, v182
    v_pk_fma_f32 v[56:57], v[18:19], v[16:17], v[56:57] op_sel_hi:[1,0,1]
    v_lshlrev_b32 v20, 16, v183
    v_and_b32 v21, 0xffff0000, v183
    v_pk_fma_f32 v[58:59], v[20:21], v[16:17], v[58:59] op_sel_hi:[1,0,1]
    s_waitcnt vmcnt(9)
    v_dot2_f32_bf16 v3, v64, v24, 0
    v_dot2_f32_bf16 v4, v70, v30, 0
    v_dot2_f32_bf16 v3, v65, v25, v3
    v_dot2_f32_bf16 v4, v71, v31, v4
    v_dot2_f32_bf16 v3, v66, v26, v3
    v_dot2_f32_bf16 v4, v72, v32, v4
    v_dot2_f32_bf16 v3, v67, v27, v3
    v_dot2_f32_bf16 v4, v73, v33, v4
    v_dot2_f32_bf16 v3, v68, v28, v3
    v_dot2_f32_bf16 v4, v74, v34, v4
    v_dot2_f32_bf16 v3, v69, v29, v3
    v_dot2_f32_bf16 v4, v75, v35, v4
    buffer_load_dwordx4 v[64:67], v1, s[32:35], s75 offen offset:0 nt
    buffer_load_dwordx4 v[68:71], v1, s[32:35], s75 offen offset:128 nt
    buffer_load_dwordx4 v[72:75], v1, s[32:35], s75 offen offset:256 nt
    v_add_f32 v3, v3, v4
    s_nop 1
    v_add_f32_dpp v3, v3, v3 quad_perm:[1,0,3,2] row_mask:0xf bank_mask:0xf
    s_nop 1
    v_add_f32_dpp v3, v3, v3 quad_perm:[2,3,0,1] row_mask:0xf bank_mask:0xf
    s_nop 1
    v_add_f32_dpp v3, v3, v3 row_half_mirror row_mask:0xf bank_mask:0xf
    v_cvt_pk_bf16_f32 v4, v3, v3
    v_lshlrev_b32 v4, 16, v4
    v_mul_f32 v4, 0x3d93cd3a, v4
    v_cvt_pk_bf16_f32 v4, v4, v4
    v_lshlrev_b32 v4, 16, v4
    v_max_f32 v5, v11, v4
    v_sub_f32 v6, v11, v5
    v_sub_f32 v7, v4, v5
    v_mul_f32 v6, 0x3fb8aa3b, v6
    v_mul_f32 v7, 0x3fb8aa3b, v7
    v_exp_f32 v14, v6
    v_exp_f32 v16, v7
    v_mov_b32 v11, v5
    v_fma_f32 v12, v12, v14, v16
    v_pk_mul_f32 v[36:37], v[36:37], v[14:15] op_sel_hi:[1,0]
    v_pk_mul_f32 v[38:39], v[38:39], v[14:15] op_sel_hi:[1,0]
    v_pk_mul_f32 v[40:41], v[40:41], v[14:15] op_sel_hi:[1,0]
    v_pk_mul_f32 v[42:43], v[42:43], v[14:15] op_sel_hi:[1,0]
    v_pk_mul_f32 v[44:45], v[44:45], v[14:15] op_sel_hi:[1,0]
    v_pk_mul_f32 v[46:47], v[46:47], v[14:15] op_sel_hi:[1,0]
    v_pk_mul_f32 v[48:49], v[48:49], v[14:15] op_sel_hi:[1,0]
    v_pk_mul_f32 v[50:51], v[50:51], v[14:15] op_sel_hi:[1,0]
    v_pk_mul_f32 v[52:53], v[52:53], v[14:15] op_sel_hi:[1,0]
    v_pk_mul_f32 v[54:55], v[54:55], v[14:15] op_sel_hi:[1,0]
    v_pk_mul_f32 v[56:57], v[56:57], v[14:15] op_sel_hi:[1,0]
    v_pk_mul_f32 v[58:59], v[58:59], v[14:15] op_sel_hi:[1,0]
    s_waitcnt vmcnt(9)
    v_lshlrev_b32 v18, 16, v76
    v_and_b32 v19, 0xffff0000, v76
    v_pk_fma_f32 v[36:37], v[18:19], v[16:17], v[36:37] op_sel_hi:[1,0,1]
    v_lshlrev_b32 v20, 16, v77
    v_and_b32 v21, 0xffff0000, v77
    v_pk_fma_f32 v[38:39], v[20:21], v[16:17], v[38:39] op_sel_hi:[1,0,1]
    v_lshlrev_b32 v18, 16, v78
    v_and_b32 v19, 0xffff0000, v78
    v_pk_fma_f32 v[40:41], v[18:19], v[16:17], v[40:41] op_sel_hi:[1,0,1]
    v_lshlrev_b32 v20, 16, v79
    v_and_b32 v21, 0xffff0000, v79
    v_pk_fma_f32 v[42:43], v[20:21], v[16:17], v[42:43] op_sel_hi:[1,0,1]
    v_lshlrev_b32 v18, 16, v80
    v_and_b32 v19, 0xffff0000, v80
    v_pk_fma_f32 v[44:45], v[18:19], v[16:17], v[44:45] op_sel_hi:[1,0,1]
    v_lshlrev_b32 v20, 16, v81
    v_and_b32 v21, 0xffff0000, v81
    v_pk_fma_f32 v[46:47], v[20:21], v[16:17], v[46:47] op_sel_hi:[1,0,1]
    v_lshlrev_b32 v18, 16, v82
    v_and_b32 v19, 0xffff0000, v82
    v_pk_fma_f32 v[48:49], v[18:19], v[16:17], v[48:49] op_sel_hi:[1,0,1]
    v_lshlrev_b32 v20, 16, v83
    v_and_b32 v21, 0xffff0000, v83
    v_pk_fma_f32 v[50:51], v[20:21], v[16:17], v[50:51] op_sel_hi:[1,0,1]
    v_lshlrev_b32 v18, 16, v84
    v_and_b32 v19, 0xffff0000, v84
    v_pk_fma_f32 v[52:53], v[18:19], v[16:17], v[52:53] op_sel_hi:[1,0,1]
    v_lshlrev_b32 v20, 16, v85
    v_and_b32 v21, 0xffff0000, v85
    v_pk_fma_f32 v[54:55], v[20:21], v[16:17], v[54:55] op_sel_hi:[1,0,1]
    v_lshlrev_b32 v18, 16, v86
    v_and_b32 v19, 0xffff0000, v86
    v_pk_fma_f32 v[56:57], v[18:19], v[16:17], v[56:57] op_sel_hi:[1,0,1]
    v_lshlrev_b32 v20, 16, v87
    v_and_b32 v21, 0xffff0000, v87
    v_pk_fma_f32 v[58:59], v[20:21], v[16:17], v[58:59] op_sel_hi:[1,0,1]
    buffer_load_dwordx4 v[76:79], v1, s[36:39], s75 offen offset:0 nt
    buffer_load_dwordx4 v[80:83], v1, s[36:39], s75 offen offset:128 nt
    buffer_load_dwordx4 v[84:87], v1, s[36:39], s75 offen offset:256 nt
    s_add_u32 s75, s75, 24576
    s_waitcnt lgkmcnt(0)
    v_dot2_f32_bf16 v3, v184, v24, 0
    v_dot2_f32_bf16 v4, v190, v30, 0
    v_dot2_f32_bf16 v3, v185, v25, v3
    v_dot2_f32_bf16 v4, v191, v31, v4
    v_dot2_f32_bf16 v3, v186, v26, v3
    v_dot2_f32_bf16 v4, v192, v32, v4
    v_dot2_f32_bf16 v3, v187, v27, v3
    v_dot2_f32_bf16 v4, v193, v33, v4
    v_dot2_f32_bf16 v3, v188, v28, v3
    v_dot2_f32_bf16 v4, v194, v34, v4
    v_dot2_f32_bf16 v3, v189, v29, v3
    v_dot2_f32_bf16 v4, v195, v35, v4
    s_nop 2
    v_add_f32 v3, v3, v4
    s_nop 1
    v_add_f32_dpp v3, v3, v3 quad_perm:[1,0,3,2] row_mask:0xf bank_mask:0xf
    s_nop 1
    v_add_f32_dpp v3, v3, v3 quad_perm:[2,3,0,1] row_mask:0xf bank_mask:0xf
    s_nop 1
    v_add_f32_dpp v3, v3, v3 row_half_mirror row_mask:0xf bank_mask:0xf
    v_cvt_pk_bf16_f32 v4, v3, v3
    v_lshlrev_b32 v4, 16, v4
    v_mul_f32 v4, 0x3d93cd3a, v4
    v_cvt_pk_bf16_f32 v4, v4, v4
    v_lshlrev_b32 v4, 16, v4
    v_max_f32 v5, v11, v4
    v_sub_f32 v6, v11, v5
    v_sub_f32 v7, v4, v5
    v_mul_f32 v6, 0x3fb8aa3b, v6
    v_mul_f32 v7, 0x3fb8aa3b, v7
    v_exp_f32 v14, v6
    v_exp_f32 v16, v7
    v_mov_b32 v11, v5
    v_fma_f32 v12, v12, v14, v16
    v_pk_mul_f32 v[36:37], v[36:37], v[14:15] op_sel_hi:[1,0]
    v_pk_mul_f32 v[38:39], v[38:39], v[14:15] op_sel_hi:[1,0]
    v_pk_mul_f32 v[40:41], v[40:41], v[14:15] op_sel_hi:[1,0]
    v_pk_mul_f32 v[42:43], v[42:43], v[14:15] op_sel_hi:[1,0]
    v_pk_mul_f32 v[44:45], v[44:45], v[14:15] op_sel_hi:[1,0]
    v_pk_mul_f32 v[46:47], v[46:47], v[14:15] op_sel_hi:[1,0]
    v_pk_mul_f32 v[48:49], v[48:49], v[14:15] op_sel_hi:[1,0]
    v_pk_mul_f32 v[50:51], v[50:51], v[14:15] op_sel_hi:[1,0]
    v_pk_mul_f32 v[52:53], v[52:53], v[14:15] op_sel_hi:[1,0]
    v_pk_mul_f32 v[54:55], v[54:55], v[14:15] op_sel_hi:[1,0]
    v_pk_mul_f32 v[56:57], v[56:57], v[14:15] op_sel_hi:[1,0]
    v_pk_mul_f32 v[58:59], v[58:59], v[14:15] op_sel_hi:[1,0]
    v_lshlrev_b32 v18, 16, v196
    v_and_b32 v19, 0xffff0000, v196
    v_pk_fma_f32 v[36:37], v[18:19], v[16:17], v[36:37] op_sel_hi:[1,0,1]
    v_lshlrev_b32 v20, 16, v197
    v_and_b32 v21, 0xffff0000, v197
    v_pk_fma_f32 v[38:39], v[20:21], v[16:17], v[38:39] op_sel_hi:[1,0,1]
    v_lshlrev_b32 v18, 16, v198
    v_and_b32 v19, 0xffff0000, v198
    v_pk_fma_f32 v[40:41], v[18:19], v[16:17], v[40:41] op_sel_hi:[1,0,1]
    v_lshlrev_b32 v20, 16, v199
    v_and_b32 v21, 0xffff0000, v199
    v_pk_fma_f32 v[42:43], v[20:21], v[16:17], v[42:43] op_sel_hi:[1,0,1]
    v_lshlrev_b32 v18, 16, v200
    v_and_b32 v19, 0xffff0000, v200
    v_pk_fma_f32 v[44:45], v[18:19], v[16:17], v[44:45] op_sel_hi:[1,0,1]
    v_lshlrev_b32 v20, 16, v201
    v_and_b32 v21, 0xffff0000, v201
    v_pk_fma_f32 v[46:47], v[20:21], v[16:17], v[46:47] op_sel_hi:[1,0,1]
    v_lshlrev_b32 v18, 16, v202
    v_and_b32 v19, 0xffff0000, v202
    v_pk_fma_f32 v[48:49], v[18:19], v[16:17], v[48:49] op_sel_hi:[1,0,1]
    v_lshlrev_b32 v20, 16, v203
    v_and_b32 v21, 0xffff0000, v203
    v_pk_fma_f32 v[50:51], v[20:21], v[16:17], v[50:51] op_sel_hi:[1,0,1]
    v_lshlrev_b32 v18, 16, v204
    v_and_b32 v19, 0xffff0000, v204
    v_pk_fma_f32 v[52:53], v[18:19], v[16:17], v[52:53] op_sel_hi:[1,0,1]
    v_lshlrev_b32 v20, 16, v205
    v_and_b32 v21, 0xffff0000, v205
    v_pk_fma_f32 v[54:55], v[20:21], v[16:17], v[54:55] op_sel_hi:[1,0,1]
    v_lshlrev_b32 v18, 16, v206
    v_and_b32 v19, 0xffff0000, v206
    v_pk_fma_f32 v[56:57], v[18:19], v[16:17], v[56:57] op_sel_hi:[1,0,1]
    v_lshlrev_b32 v20, 16, v207
    v_and_b32 v21, 0xffff0000, v207
    v_pk_fma_f32 v[58:59], v[20:21], v[16:17], v[58:59] op_sel_hi:[1,0,1]
    s_waitcnt lgkmcnt(0)
    v_dot2_f32_bf16 v3, v208, v24, 0
    v_dot2_f32_bf16 v4, v214, v30, 0
    v_dot2_f32_bf16 v3, v209, v25, v3
    v_dot2_f32_bf16 v4, v215, v31, v4
    v_dot2_f32_bf16 v3, v210, v26, v3
    v_dot2_f32_bf16 v4, v216, v32, v4
    v_dot2_f32_bf16 v3, v211, v27, v3
    v_dot2_f32_bf16 v4, v217, v33, v4
    v_dot2_f32_bf16 v3, v212, v28, v3
    v_dot2_f32_bf16 v4, v218, v34, v4
    v_dot2_f32_bf16 v3, v213, v29, v3
    v_dot2_f32_bf16 v4, v219, v35, v4
    s_nop 2
    v_add_f32 v3, v3, v4
    s_nop 1
    v_add_f32_dpp v3, v3, v3 quad_perm:[1,0,3,2] row_mask:0xf bank_mask:0xf
    s_nop 1
    v_add_f32_dpp v3, v3, v3 quad_perm:[2,3,0,1] row_mask:0xf bank_mask:0xf
    s_nop 1
    v_add_f32_dpp v3, v3, v3 row_half_mirror row_mask:0xf bank_mask:0xf
    v_cvt_pk_bf16_f32 v4, v3, v3
    v_lshlrev_b32 v4, 16, v4
    v_mul_f32 v4, 0x3d93cd3a, v4
    v_cvt_pk_bf16_f32 v4, v4, v4
    v_lshlrev_b32 v4, 16, v4
    v_max_f32 v5, v11, v4
    v_sub_f32 v6, v11, v5
    v_sub_f32 v7, v4, v5
    v_mul_f32 v6, 0x3fb8aa3b, v6
    v_mul_f32 v7, 0x3fb8aa3b, v7
    v_exp_f32 v14, v6
    v_exp_f32 v16, v7
    v_mov_b32 v11, v5
    v_fma_f32 v12, v12, v14, v16
    v_pk_mul_f32 v[36:37], v[36:37], v[14:15] op_sel_hi:[1,0]
    v_pk_mul_f32 v[38:39], v[38:39], v[14:15] op_sel_hi:[1,0]
    v_pk_mul_f32 v[40:41], v[40:41], v[14:15] op_sel_hi:[1,0]
    v_pk_mul_f32 v[42:43], v[42:43], v[14:15] op_sel_hi:[1,0]
    v_pk_mul_f32 v[44:45], v[44:45], v[14:15] op_sel_hi:[1,0]
    v_pk_mul_f32 v[46:47], v[46:47], v[14:15] op_sel_hi:[1,0]
    v_pk_mul_f32 v[48:49], v[48:49], v[14:15] op_sel_hi:[1,0]
    v_pk_mul_f32 v[50:51], v[50:51], v[14:15] op_sel_hi:[1,0]
    v_pk_mul_f32 v[52:53], v[52:53], v[14:15] op_sel_hi:[1,0]
    v_pk_mul_f32 v[54:55], v[54:55], v[14:15] op_sel_hi:[1,0]
    v_pk_mul_f32 v[56:57], v[56:57], v[14:15] op_sel_hi:[1,0]
    v_pk_mul_f32 v[58:59], v[58:59], v[14:15] op_sel_hi:[1,0]
    v_lshlrev_b32 v18, 16, v220
    v_and_b32 v19, 0xffff0000, v220
    v_pk_fma_f32 v[36:37], v[18:19], v[16:17], v[36:37] op_sel_hi:[1,0,1]
    v_lshlrev_b32 v20, 16, v221
    v_and_b32 v21, 0xffff0000, v221
    v_pk_fma_f32 v[38:39], v[20:21], v[16:17], v[38:39] op_sel_hi:[1,0,1]
    v_lshlrev_b32 v18, 16, v222
    v_and_b32 v19, 0xffff0000, v222
    v_pk_fma_f32 v[40:41], v[18:19], v[16:17], v[40:41] op_sel_hi:[1,0,1]
    v_lshlrev_b32 v20, 16, v223
    v_and_b32 v21, 0xffff0000, v223
    v_pk_fma_f32 v[42:43], v[20:21], v[16:17], v[42:43] op_sel_hi:[1,0,1]
    v_lshlrev_b32 v18, 16, v224
    v_and_b32 v19, 0xffff0000, v224
    v_pk_fma_f32 v[44:45], v[18:19], v[16:17], v[44:45] op_sel_hi:[1,0,1]
    v_lshlrev_b32 v20, 16, v225
    v_and_b32 v21, 0xffff0000, v225
    v_pk_fma_f32 v[46:47], v[20:21], v[16:17], v[46:47] op_sel_hi:[1,0,1]
    v_lshlrev_b32 v18, 16, v226
    v_and_b32 v19, 0xffff0000, v226
    v_pk_fma_f32 v[48:49], v[18:19], v[16:17], v[48:49] op_sel_hi:[1,0,1]
    v_lshlrev_b32 v20, 16, v227
    v_and_b32 v21, 0xffff0000, v227
    v_pk_fma_f32 v[50:51], v[20:21], v[16:17], v[50:51] op_sel_hi:[1,0,1]
    v_lshlrev_b32 v18, 16, v228
    v_and_b32 v19, 0xffff0000, v228
    v_pk_fma_f32 v[52:53], v[18:19], v[16:17], v[52:53] op_sel_hi:[1,0,1]
    v_lshlrev_b32 v20, 16, v229
    v_and_b32 v21, 0xffff0000, v229
    v_pk_fma_f32 v[54:55], v[20:21], v[16:17], v[54:55] op_sel_hi:[1,0,1]
    v_lshlrev_b32 v18, 16, v230
    v_and_b32 v19, 0xffff0000, v230
    v_pk_fma_f32 v[56:57], v[18:19], v[16:17], v[56:57] op_sel_hi:[1,0,1]
    v_lshlrev_b32 v20, 16, v231
    v_and_b32 v21, 0xffff0000, v231
    v_pk_fma_f32 v[58:59], v[20:21], v[16:17], v[58:59] op_sel_hi:[1,0,1]
    s_waitcnt vmcnt(9)
    v_dot2_f32_bf16 v3, v88, v24, 0
    v_dot2_f32_bf16 v4, v94, v30, 0
    v_dot2_f32_bf16 v3, v89, v25, v3
    v_dot2_f32_bf16 v4, v95, v31, v4
    v_dot2_f32_bf16 v3, v90, v26, v3
    v_dot2_f32_bf16 v4, v96, v32, v4
    v_dot2_f32_bf16 v3, v91, v27, v3
    v_dot2_f32_bf16 v4, v97, v33, v4
    v_dot2_f32_bf16 v3, v92, v28, v3
    v_dot2_f32_bf16 v4, v98, v34, v4
    v_dot2_f32_bf16 v3, v93, v29, v3
    v_dot2_f32_bf16 v4, v99, v35, v4
    buffer_load_dwordx4 v[88:91], v1, s[32:35], s75 offen offset:0 nt
    buffer_load_dwordx4 v[92:95], v1, s[32:35], s75 offen offset:128 nt
    buffer_load_dwordx4 v[96:99], v1, s[32:35], s75 offen offset:256 nt
    v_add_f32 v3, v3, v4
    s_nop 1
    v_add_f32_dpp v3, v3, v3 quad_perm:[1,0,3,2] row_mask:0xf bank_mask:0xf
    s_nop 1
    v_add_f32_dpp v3, v3, v3 quad_perm:[2,3,0,1] row_mask:0xf bank_mask:0xf
    s_nop 1
    v_add_f32_dpp v3, v3, v3 row_half_mirror row_mask:0xf bank_mask:0xf
    v_cvt_pk_bf16_f32 v4, v3, v3
    v_lshlrev_b32 v4, 16, v4
    v_mul_f32 v4, 0x3d93cd3a, v4
    v_cvt_pk_bf16_f32 v4, v4, v4
    v_lshlrev_b32 v4, 16, v4
    v_max_f32 v5, v11, v4
    v_sub_f32 v6, v11, v5
    v_sub_f32 v7, v4, v5
    v_mul_f32 v6, 0x3fb8aa3b, v6
    v_mul_f32 v7, 0x3fb8aa3b, v7
    v_exp_f32 v14, v6
    v_exp_f32 v16, v7
    v_mov_b32 v11, v5
    v_fma_f32 v12, v12, v14, v16
    v_pk_mul_f32 v[36:37], v[36:37], v[14:15] op_sel_hi:[1,0]
    v_pk_mul_f32 v[38:39], v[38:39], v[14:15] op_sel_hi:[1,0]
    v_pk_mul_f32 v[40:41], v[40:41], v[14:15] op_sel_hi:[1,0]
    v_pk_mul_f32 v[42:43], v[42:43], v[14:15] op_sel_hi:[1,0]
    v_pk_mul_f32 v[44:45], v[44:45], v[14:15] op_sel_hi:[1,0]
    v_pk_mul_f32 v[46:47], v[46:47], v[14:15] op_sel_hi:[1,0]
    v_pk_mul_f32 v[48:49], v[48:49], v[14:15] op_sel_hi:[1,0]
    v_pk_mul_f32 v[50:51], v[50:51], v[14:15] op_sel_hi:[1,0]
    v_pk_mul_f32 v[52:53], v[52:53], v[14:15] op_sel_hi:[1,0]
    v_pk_mul_f32 v[54:55], v[54:55], v[14:15] op_sel_hi:[1,0]
    v_pk_mul_f32 v[56:57], v[56:57], v[14:15] op_sel_hi:[1,0]
    v_pk_mul_f32 v[58:59], v[58:59], v[14:15] op_sel_hi:[1,0]
    s_waitcnt vmcnt(9)
    v_lshlrev_b32 v18, 16, v100
    v_and_b32 v19, 0xffff0000, v100
    v_pk_fma_f32 v[36:37], v[18:19], v[16:17], v[36:37] op_sel_hi:[1,0,1]
    v_lshlrev_b32 v20, 16, v101
    v_and_b32 v21, 0xffff0000, v101
    v_pk_fma_f32 v[38:39], v[20:21], v[16:17], v[38:39] op_sel_hi:[1,0,1]
    v_lshlrev_b32 v18, 16, v102
    v_and_b32 v19, 0xffff0000, v102
    v_pk_fma_f32 v[40:41], v[18:19], v[16:17], v[40:41] op_sel_hi:[1,0,1]
    v_lshlrev_b32 v20, 16, v103
    v_and_b32 v21, 0xffff0000, v103
    v_pk_fma_f32 v[42:43], v[20:21], v[16:17], v[42:43] op_sel_hi:[1,0,1]
    v_lshlrev_b32 v18, 16, v104
    v_and_b32 v19, 0xffff0000, v104
    v_pk_fma_f32 v[44:45], v[18:19], v[16:17], v[44:45] op_sel_hi:[1,0,1]
    v_lshlrev_b32 v20, 16, v105
    v_and_b32 v21, 0xffff0000, v105
    v_pk_fma_f32 v[46:47], v[20:21], v[16:17], v[46:47] op_sel_hi:[1,0,1]
    v_lshlrev_b32 v18, 16, v106
    v_and_b32 v19, 0xffff0000, v106
    v_pk_fma_f32 v[48:49], v[18:19], v[16:17], v[48:49] op_sel_hi:[1,0,1]
    v_lshlrev_b32 v20, 16, v107
    v_and_b32 v21, 0xffff0000, v107
    v_pk_fma_f32 v[50:51], v[20:21], v[16:17], v[50:51] op_sel_hi:[1,0,1]
    v_lshlrev_b32 v18, 16, v108
    v_and_b32 v19, 0xffff0000, v108
    v_pk_fma_f32 v[52:53], v[18:19], v[16:17], v[52:53] op_sel_hi:[1,0,1]
    v_lshlrev_b32 v20, 16, v109
    v_and_b32 v21, 0xffff0000, v109
    v_pk_fma_f32 v[54:55], v[20:21], v[16:17], v[54:55] op_sel_hi:[1,0,1]
    v_lshlrev_b32 v18, 16, v110
    v_and_b32 v19, 0xffff0000, v110
    v_pk_fma_f32 v[56:57], v[18:19], v[16:17], v[56:57] op_sel_hi:[1,0,1]
    v_lshlrev_b32 v20, 16, v111
    v_and_b32 v21, 0xffff0000, v111
    v_pk_fma_f32 v[58:59], v[20:21], v[16:17], v[58:59] op_sel_hi:[1,0,1]
    buffer_load_dwordx4 v[100:103], v1, s[36:39], s75 offen offset:0 nt
    buffer_load_dwordx4 v[104:107], v1, s[36:39], s75 offen offset:128 nt
    buffer_load_dwordx4 v[108:111], v1, s[36:39], s75 offen offset:256 nt
    s_add_u32 s75, s75, 24576
    s_waitcnt lgkmcnt(0)
    v_dot2_f32_bf16 v3, v232, v24, 0
    v_dot2_f32_bf16 v4, v238, v30, 0
    v_dot2_f32_bf16 v3, v233, v25, v3
    v_dot2_f32_bf16 v4, v239, v31, v4
    v_dot2_f32_bf16 v3, v234, v26, v3
    v_dot2_f32_bf16 v4, v240, v32, v4
    v_dot2_f32_bf16 v3, v235, v27, v3
    v_dot2_f32_bf16 v4, v241, v33, v4
    v_dot2_f32_bf16 v3, v236, v28, v3
    v_dot2_f32_bf16 v4, v242, v34, v4
    v_dot2_f32_bf16 v3, v237, v29, v3
    v_dot2_f32_bf16 v4, v243, v35, v4
    s_nop 2
    v_add_f32 v3, v3, v4
    s_nop 1
    v_add_f32_dpp v3, v3, v3 quad_perm:[1,0,3,2] row_mask:0xf bank_mask:0xf
    s_nop 1
    v_add_f32_dpp v3, v3, v3 quad_perm:[2,3,0,1] row_mask:0xf bank_mask:0xf
    s_nop 1
    v_add_f32_dpp v3, v3, v3 row_half_mirror row_mask:0xf bank_mask:0xf
    v_cvt_pk_bf16_f32 v4, v3, v3
    v_lshlrev_b32 v4, 16, v4
    v_mul_f32 v4, 0x3d93cd3a, v4
    v_cvt_pk_bf16_f32 v4, v4, v4
    v_lshlrev_b32 v4, 16, v4
    v_max_f32 v5, v11, v4
    v_sub_f32 v6, v11, v5
    v_sub_f32 v7, v4, v5
    v_mul_f32 v6, 0x3fb8aa3b, v6
    v_mul_f32 v7, 0x3fb8aa3b, v7
    v_exp_f32 v14, v6
    v_exp_f32 v16, v7
    v_mov_b32 v11, v5
    v_fma_f32 v12, v12, v14, v16
    v_pk_mul_f32 v[36:37], v[36:37], v[14:15] op_sel_hi:[1,0]
    v_pk_mul_f32 v[38:39], v[38:39], v[14:15] op_sel_hi:[1,0]
    v_pk_mul_f32 v[40:41], v[40:41], v[14:15] op_sel_hi:[1,0]
    v_pk_mul_f32 v[42:43], v[42:43], v[14:15] op_sel_hi:[1,0]
    v_pk_mul_f32 v[44:45], v[44:45], v[14:15] op_sel_hi:[1,0]
    v_pk_mul_f32 v[46:47], v[46:47], v[14:15] op_sel_hi:[1,0]
    v_pk_mul_f32 v[48:49], v[48:49], v[14:15] op_sel_hi:[1,0]
    v_pk_mul_f32 v[50:51], v[50:51], v[14:15] op_sel_hi:[1,0]
    v_pk_mul_f32 v[52:53], v[52:53], v[14:15] op_sel_hi:[1,0]
    v_pk_mul_f32 v[54:55], v[54:55], v[14:15] op_sel_hi:[1,0]
    v_pk_mul_f32 v[56:57], v[56:57], v[14:15] op_sel_hi:[1,0]
    v_pk_mul_f32 v[58:59], v[58:59], v[14:15] op_sel_hi:[1,0]
    v_lshlrev_b32 v18, 16, v244
    v_and_b32 v19, 0xffff0000, v244
    v_pk_fma_f32 v[36:37], v[18:19], v[16:17], v[36:37] op_sel_hi:[1,0,1]
    v_lshlrev_b32 v20, 16, v245
    v_and_b32 v21, 0xffff0000, v245
    v_pk_fma_f32 v[38:39], v[20:21], v[16:17], v[38:39] op_sel_hi:[1,0,1]
    v_lshlrev_b32 v18, 16, v246
    v_and_b32 v19, 0xffff0000, v246
    v_pk_fma_f32 v[40:41], v[18:19], v[16:17], v[40:41] op_sel_hi:[1,0,1]
    v_lshlrev_b32 v20, 16, v247
    v_and_b32 v21, 0xffff0000, v247
    v_pk_fma_f32 v[42:43], v[20:21], v[16:17], v[42:43] op_sel_hi:[1,0,1]
    v_lshlrev_b32 v18, 16, v248
    v_and_b32 v19, 0xffff0000, v248
    v_pk_fma_f32 v[44:45], v[18:19], v[16:17], v[44:45] op_sel_hi:[1,0,1]
    v_lshlrev_b32 v20, 16, v249
    v_and_b32 v21, 0xffff0000, v249
    v_pk_fma_f32 v[46:47], v[20:21], v[16:17], v[46:47] op_sel_hi:[1,0,1]
    v_lshlrev_b32 v18, 16, v250
    v_and_b32 v19, 0xffff0000, v250
    v_pk_fma_f32 v[48:49], v[18:19], v[16:17], v[48:49] op_sel_hi:[1,0,1]
    v_lshlrev_b32 v20, 16, v251
    v_and_b32 v21, 0xffff0000, v251
    v_pk_fma_f32 v[50:51], v[20:21], v[16:17], v[50:51] op_sel_hi:[1,0,1]
    v_lshlrev_b32 v18, 16, v252
    v_and_b32 v19, 0xffff0000, v252
    v_pk_fma_f32 v[52:53], v[18:19], v[16:17], v[52:53] op_sel_hi:[1,0,1]
    v_lshlrev_b32 v20, 16, v253
    v_and_b32 v21, 0xffff0000, v253
    v_pk_fma_f32 v[54:55], v[20:21], v[16:17], v[54:55] op_sel_hi:[1,0,1]
    v_lshlrev_b32 v18, 16, v254
    v_and_b32 v19, 0xffff0000, v254
    v_pk_fma_f32 v[56:57], v[18:19], v[16:17], v[56:57] op_sel_hi:[1,0,1]
    v_lshlrev_b32 v20, 16, v255
    v_and_b32 v21, 0xffff0000, v255
    v_pk_fma_f32 v[58:59], v[20:21], v[16:17], v[58:59] op_sel_hi:[1,0,1]
    v_mov_b32 v3, 1
    s_mov_b64 exec, 1
    ds_add_u32 v2, v3 offset:63500
    s_mov_b64 exec, -1
    s_mov_b32 s68, 5
    s_cmp_eq_u32 s73, 5
    s_cselect_b32 s77, 7, 15
    s_add_u32 s68, s68, 304
L_loopA:
    s_waitcnt vmcnt(9)
    v_dot2_f32_bf16 v3, v64, v24, 0
    v_dot2_f32_bf16 v4, v70, v30, 0
    v_dot2_f32_bf16 v3, v65, v25, v3
    v_dot2_f32_bf16 v4, v71, v31, v4
    v_dot2_f32_bf16 v3, v66, v26, v3
    v_dot2_f32_bf16 v4, v72, v32, v4
    v_dot2_f32_bf16 v3, v67, v27, v3
    v_dot2_f32_bf16 v4, v73, v33, v4
    v_dot2_f32_bf16 v3, v68, v28, v3
    v_dot2_f32_bf16 v4, v74, v34, v4
    v_dot2_f32_bf16 v3, v69, v29, v3
    v_dot2_f32_bf16 v4, v75, v35, v4
    buffer_load_dwordx4 v[64:67], v1, s[32:35], s75 offen offset:0 nt
    buffer_load_dwordx4 v[68:71], v1, s[32:35], s75 offen offset:128 nt
    buffer_load_dwordx4 v[72:75], v1, s[32:35], s75 offen offset:256 nt
    v_add_f32 v3, v3, v4
    s_nop 1
    v_add_f32_dpp v3, v3, v3 quad_perm:[1,0,3,2] row_mask:0xf bank_mask:0xf
    s_nop 1
    v_add_f32_dpp v3, v3, v3 quad_perm:[2,3,0,1] row_mask:0xf bank_mask:0xf
    s_nop 1
    v_add_f32_dpp v3, v3, v3 row_half_mirror row_mask:0xf bank_mask:0xf
    v_cvt_pk_bf16_f32 v4, v3, v3
    v_lshlrev_b32 v4, 16, v4
    v_mul_f32 v4, 0x3d93cd3a, v4
    v_cvt_pk_bf16_f32 v4, v4, v4
    v_lshlrev_b32 v4, 16, v4
    v_max_f32 v5, v11, v4
    v_sub_f32 v6, v11, v5
    v_sub_f32 v7, v4, v5
    v_mul_f32 v6, 0x3fb8aa3b, v6
    v_mul_f32 v7, 0x3fb8aa3b, v7
    v_exp_f32 v14, v6
    v_exp_f32 v16, v7
    v_mov_b32 v11, v5
    v_fma_f32 v12, v12, v14, v16
    v_pk_mul_f32 v[36:37], v[36:37], v[14:15] op_sel_hi:[1,0]
    v_pk_mul_f32 v[38:39], v[38:39], v[14:15] op_sel_hi:[1,0]
    v_pk_mul_f32 v[40:41], v[40:41], v[14:15] op_sel_hi:[1,0]
    v_pk_mul_f32 v[42:43], v[42:43], v[14:15] op_sel_hi:[1,0]
    v_pk_mul_f32 v[44:45], v[44:45], v[14:15] op_sel_hi:[1,0]
    v_pk_mul_f32 v[46:47], v[46:47], v[14:15] op_sel_hi:[1,0]
    v_pk_mul_f32 v[48:49], v[48:49], v[14:15] op_sel_hi:[1,0]
    v_pk_mul_f32 v[50:51], v[50:51], v[14:15] op_sel_hi:[1,0]
    v_pk_mul_f32 v[52:53], v[52:53], v[14:15] op_sel_hi:[1,0]
    v_pk_mul_f32 v[54:55], v[54:55], v[14:15] op_sel_hi:[1,0]
    v_pk_mul_f32 v[56:57], v[56:57], v[14:15] op_sel_hi:[1,0]
    v_pk_mul_f32 v[58:59], v[58:59], v[14:15] op_sel_hi:[1,0]
    s_waitcnt vmcnt(9)
    v_lshlrev_b32 v18, 16, v76
    v_and_b32 v19, 0xffff0000, v76
    v_pk_fma_f32 v[36:37], v[18:19], v[16:17], v[36:37] op_sel_hi:[1,0,1]
    v_lshlrev_b32 v20, 16, v77
    v_and_b32 v21, 0xffff0000, v77
    v_pk_fma_f32 v[38:39], v[20:21], v[16:17], v[38:39] op_sel_hi:[1,0,1]
    v_lshlrev_b32 v18, 16, v78
    v_and_b32 v19, 0xffff0000, v78
    v_pk_fma_f32 v[40:41], v[18:19], v[16:17], v[40:41] op_sel_hi:[1,0,1]
    v_lshlrev_b32 v20, 16, v79
    v_and_b32 v21, 0xffff0000, v79
    v_pk_fma_f32 v[42:43], v[20:21], v[16:17], v[42:43] op_sel_hi:[1,0,1]
    v_lshlrev_b32 v18, 16, v80
    v_and_b32 v19, 0xffff0000, v80
    v_pk_fma_f32 v[44:45], v[18:19], v[16:17], v[44:45] op_sel_hi:[1,0,1]
    v_lshlrev_b32 v20, 16, v81
    v_and_b32 v21, 0xffff0000, v81
    v_pk_fma_f32 v[46:47], v[20:21], v[16:17], v[46:47] op_sel_hi:[1,0,1]
    v_lshlrev_b32 v18, 16, v82
    v_and_b32 v19, 0xffff0000, v82
    v_pk_fma_f32 v[48:49], v[18:19], v[16:17], v[48:49] op_sel_hi:[1,0,1]
    v_lshlrev_b32 v20, 16, v83
    v_and_b32 v21, 0xffff0000, v83
    v_pk_fma_f32 v[50:51], v[20:21], v[16:17], v[50:51] op_sel_hi:[1,0,1]
    v_lshlrev_b32 v18, 16, v84
    v_and_b32 v19, 0xffff0000, v84
    v_pk_fma_f32 v[52:53], v[18:19], v[16:17], v[52:53] op_sel_hi:[1,0,1]
    v_lshlrev_b32 v20, 16, v85
    v_and_b32 v21, 0xffff0000, v85
    v_pk_fma_f32 v[54:55], v[20:21], v[16:17], v[54:55] op_sel_hi:[1,0,1]
    v_lshlrev_b32 v18, 16, v86
    v_and_b32 v19, 0xffff0000, v86
    v_pk_fma_f32 v[56:57], v[18:19], v[16:17], v[56:57] op_sel_hi:[1,0,1]
    v_lshlrev_b32 v20, 16, v87
    v_and_b32 v21, 0xffff0000, v87
    v_pk_fma_f32 v[58:59], v[20:21], v[16:17], v[58:59] op_sel_hi:[1,0,1]
    buffer_load_dwordx4 v[76:79], v1, s[36:39], s75 offen offset:0 nt
    buffer_load_dwordx4 v[80:83], v1, s[36:39], s75 offen offset:128 nt
    buffer_load_dwordx4 v[84:87], v1, s[36:39], s75 offen offset:256 nt
    s_add_u32 s75, s75, 24576
    s_waitcnt vmcnt(9)
    v_dot2_f32_bf16 v3, v88, v24, 0
    v_dot2_f32_bf16 v4, v94, v30, 0
    v_dot2_f32_bf16 v3, v89, v25, v3
    v_dot2_f32_bf16 v4, v95, v31, v4
    v_dot2_f32_bf16 v3, v90, v26, v3
    v_dot2_f32_bf16 v4, v96, v32, v4
    v_dot2_f32_bf16 v3, v91, v27, v3
    v_dot2_f32_bf16 v4, v97, v33, v4
    v_dot2_f32_bf16 v3, v92, v28, v3
    v_dot2_f32_bf16 v4, v98, v34, v4
    v_dot2_f32_bf16 v3, v93, v29, v3
    v_dot2_f32_bf16 v4, v99, v35, v4
    buffer_load_dwordx4 v[88:91], v1, s[32:35], s75 offen offset:0 nt
    buffer_load_dwordx4 v[92:95], v1, s[32:35], s75 offen offset:128 nt
    buffer_load_dwordx4 v[96:99], v1, s[32:35], s75 offen offset:256 nt
    v_add_f32 v3, v3, v4
    s_nop 1
    v_add_f32_dpp v3, v3, v3 quad_perm:[1,0,3,2] row_mask:0xf bank_mask:0xf
    s_nop 1
    v_add_f32_dpp v3, v3, v3 quad_perm:[2,3,0,1] row_mask:0xf bank_mask:0xf
    s_nop 1
    v_add_f32_dpp v3, v3, v3 row_half_mirror row_mask:0xf bank_mask:0xf
    v_cvt_pk_bf16_f32 v4, v3, v3
    v_lshlrev_b32 v4, 16, v4
    v_mul_f32 v4, 0x3d93cd3a, v4
    v_cvt_pk_bf16_f32 v4, v4, v4
    v_lshlrev_b32 v4, 16, v4
    v_max_f32 v5, v11, v4
    v_sub_f32 v6, v11, v5
    v_sub_f32 v7, v4, v5
    v_mul_f32 v6, 0x3fb8aa3b, v6
    v_mul_f32 v7, 0x3fb8aa3b, v7
    v_exp_f32 v14, v6
    v_exp_f32 v16, v7
    v_mov_b32 v11, v5
    v_fma_f32 v12, v12, v14, v16
    v_pk_mul_f32 v[36:37], v[36:37], v[14:15] op_sel_hi:[1,0]
    v_pk_mul_f32 v[38:39], v[38:39], v[14:15] op_sel_hi:[1,0]
    v_pk_mul_f32 v[40:41], v[40:41], v[14:15] op_sel_hi:[1,0]
    v_pk_mul_f32 v[42:43], v[42:43], v[14:15] op_sel_hi:[1,0]
    v_pk_mul_f32 v[44:45], v[44:45], v[14:15] op_sel_hi:[1,0]
    v_pk_mul_f32 v[46:47], v[46:47], v[14:15] op_sel_hi:[1,0]
    v_pk_mul_f32 v[48:49], v[48:49], v[14:15] op_sel_hi:[1,0]
    v_pk_mul_f32 v[50:51], v[50:51], v[14:15] op_sel_hi:[1,0]
    v_pk_mul_f32 v[52:53], v[52:53], v[14:15] op_sel_hi:[1,0]
    v_pk_mul_f32 v[54:55], v[54:55], v[14:15] op_sel_hi:[1,0]
    v_pk_mul_f32 v[56:57], v[56:57], v[14:15] op_sel_hi:[1,0]
    v_pk_mul_f32 v[58:59], v[58:59], v[14:15] op_sel_hi:[1,0]
    s_waitcnt vmcnt(9)
    v_lshlrev_b32 v18, 16, v100
    v_and_b32 v19, 0xffff0000, v100
    v_pk_fma_f32 v[36:37], v[18:19], v[16:17], v[36:37] op_sel_hi:[1,0,1]
    v_lshlrev_b32 v20, 16, v101
    v_and_b32 v21, 0xffff0000, v101
    v_pk_fma_f32 v[38:39], v[20:21], v[16:17], v[38:39] op_sel_hi:[1,0,1]
    v_lshlrev_b32 v18, 16, v102
    v_and_b32 v19, 0xffff0000, v102
    v_pk_fma_f32 v[40:41], v[18:19], v[16:17], v[40:41] op_sel_hi:[1,0,1]
    v_lshlrev_b32 v20, 16, v103
    v_and_b32 v21, 0xffff0000, v103
    v_pk_fma_f32 v[42:43], v[20:21], v[16:17], v[42:43] op_sel_hi:[1,0,1]
    v_lshlrev_b32 v18, 16, v104
    v_and_b32 v19, 0xffff0000, v104
    v_pk_fma_f32 v[44:45], v[18:19], v[16:17], v[44:45] op_sel_hi:[1,0,1]
    v_lshlrev_b32 v20, 16, v105
    v_and_b32 v21, 0xffff0000, v105
    v_pk_fma_f32 v[46:47], v[20:21], v[16:17], v[46:47] op_sel_hi:[1,0,1]
    v_lshlrev_b32 v18, 16, v106
    v_and_b32 v19, 0xffff0000, v106
    v_pk_fma_f32 v[48:49], v[18:19], v[16:17], v[48:49] op_sel_hi:[1,0,1]
    v_lshlrev_b32 v20, 16, v107
    v_and_b32 v21, 0xffff0000, v107
    v_pk_fma_f32 v[50:51], v[20:21], v[16:17], v[50:51] op_sel_hi:[1,0,1]
    v_lshlrev_b32 v18, 16, v108
    v_and_b32 v19, 0xffff0000, v108
    v_pk_fma_f32 v[52:53], v[18:19], v[16:17], v[52:53] op_sel_hi:[1,0,1]
    v_lshlrev_b32 v20, 16, v109
    v_and_b32 v21, 0xffff0000, v109
    v_pk_fma_f32 v[54:55], v[20:21], v[16:17], v[54:55] op_sel_hi:[1,0,1]
    v_lshlrev_b32 v18, 16, v110
    v_and_b32 v19, 0xffff0000, v110
    v_pk_fma_f32 v[56:57], v[18:19], v[16:17], v[56:57] op_sel_hi:[1,0,1]
    v_lshlrev_b32 v20, 16, v111
    v_and_b32 v21, 0xffff0000, v111
    v_pk_fma_f32 v[58:59], v[20:21], v[16:17], v[58:59] op_sel_hi:[1,0,1]
    buffer_load_dwordx4 v[100:103], v1, s[36:39], s75 offen offset:0 nt
    buffer_load_dwordx4 v[104:107], v1, s[36:39], s75 offen offset:128 nt
    buffer_load_dwordx4 v[108:111], v1, s[36:39], s75 offen offset:256 nt
    s_add_u32 s75, s75, 24576
    s_sub_u32 s77, s77, 1
    s_cmp_lg_u32 s77, 0
    s_cbranch_scc1 L_loopA
    s_mov_b32 s65, 2
    s_atomic_add s65, s[66:67], 0 glc
    s_waitcnt vmcnt(9)
    v_dot2_f32_bf16 v3, v64, v24, 0
    v_dot2_f32_bf16 v4, v70, v30, 0
    v_dot2_f32_bf16 v3, v65, v25, v3
    v_dot2_f32_bf16 v4, v71, v31, v4
    v_dot2_f32_bf16 v3, v66, v26, v3
    v_dot2_f32_bf16 v4, v72, v32, v4
    v_dot2_f32_bf16 v3, v67, v27, v3
    v_dot2_f32_bf16 v4, v73, v33, v4
    v_dot2_f32_bf16 v3, v68, v28, v3
    v_dot2_f32_bf16 v4, v74, v34, v4
    v_dot2_f32_bf16 v3, v69, v29, v3
    v_dot2_f32_bf16 v4, v75, v35, v4
    buffer_load_dwordx4 v[64:67], v1, s[32:35], s75 offen offset:0 nt
    buffer_load_dwordx4 v[68:71], v1, s[32:35], s75 offen offset:128 nt
    buffer_load_dwordx4 v[72:75], v1, s[32:35], s75 offen offset:256 nt
    v_add_f32 v3, v3, v4
    s_nop 1
    v_add_f32_dpp v3, v3, v3 quad_perm:[1,0,3,2] row_mask:0xf bank_mask:0xf
    s_nop 1
    v_add_f32_dpp v3, v3, v3 quad_perm:[2,3,0,1] row_mask:0xf bank_mask:0xf
    s_nop 1
    v_add_f32_dpp v3, v3, v3 row_half_mirror row_mask:0xf bank_mask:0xf
    v_cvt_pk_bf16_f32 v4, v3, v3
    v_lshlrev_b32 v4, 16, v4
    v_mul_f32 v4, 0x3d93cd3a, v4
    v_cvt_pk_bf16_f32 v4, v4, v4
    v_lshlrev_b32 v4, 16, v4
    v_max_f32 v5, v11, v4
    v_sub_f32 v6, v11, v5
    v_sub_f32 v7, v4, v5
    v_mul_f32 v6, 0x3fb8aa3b, v6
    v_mul_f32 v7, 0x3fb8aa3b, v7
    v_exp_f32 v14, v6
    v_exp_f32 v16, v7
    v_mov_b32 v11, v5
    v_fma_f32 v12, v12, v14, v16
    v_pk_mul_f32 v[36:37], v[36:37], v[14:15] op_sel_hi:[1,0]
    v_pk_mul_f32 v[38:39], v[38:39], v[14:15] op_sel_hi:[1,0]
    v_pk_mul_f32 v[40:41], v[40:41], v[14:15] op_sel_hi:[1,0]
    v_pk_mul_f32 v[42:43], v[42:43], v[14:15] op_sel_hi:[1,0]
    v_pk_mul_f32 v[44:45], v[44:45], v[14:15] op_sel_hi:[1,0]
    v_pk_mul_f32 v[46:47], v[46:47], v[14:15] op_sel_hi:[1,0]
    v_pk_mul_f32 v[48:49], v[48:49], v[14:15] op_sel_hi:[1,0]
    v_pk_mul_f32 v[50:51], v[50:51], v[14:15] op_sel_hi:[1,0]
    v_pk_mul_f32 v[52:53], v[52:53], v[14:15] op_sel_hi:[1,0]
    v_pk_mul_f32 v[54:55], v[54:55], v[14:15] op_sel_hi:[1,0]
    v_pk_mul_f32 v[56:57], v[56:57], v[14:15] op_sel_hi:[1,0]
    v_pk_mul_f32 v[58:59], v[58:59], v[14:15] op_sel_hi:[1,0]
    s_waitcnt vmcnt(9)
    v_lshlrev_b32 v18, 16, v76
    v_and_b32 v19, 0xffff0000, v76
    v_pk_fma_f32 v[36:37], v[18:19], v[16:17], v[36:37] op_sel_hi:[1,0,1]
    v_lshlrev_b32 v20, 16, v77
    v_and_b32 v21, 0xffff0000, v77
    v_pk_fma_f32 v[38:39], v[20:21], v[16:17], v[38:39] op_sel_hi:[1,0,1]
    v_lshlrev_b32 v18, 16, v78
    v_and_b32 v19, 0xffff0000, v78
    v_pk_fma_f32 v[40:41], v[18:19], v[16:17], v[40:41] op_sel_hi:[1,0,1]
    v_lshlrev_b32 v20, 16, v79
    v_and_b32 v21, 0xffff0000, v79
    v_pk_fma_f32 v[42:43], v[20:21], v[16:17], v[42:43] op_sel_hi:[1,0,1]
    v_lshlrev_b32 v18, 16, v80
    v_and_b32 v19, 0xffff0000, v80
    v_pk_fma_f32 v[44:45], v[18:19], v[16:17], v[44:45] op_sel_hi:[1,0,1]
    v_lshlrev_b32 v20, 16, v81
    v_and_b32 v21, 0xffff0000, v81
    v_pk_fma_f32 v[46:47], v[20:21], v[16:17], v[46:47] op_sel_hi:[1,0,1]
    v_lshlrev_b32 v18, 16, v82
    v_and_b32 v19, 0xffff0000, v82
    v_pk_fma_f32 v[48:49], v[18:19], v[16:17], v[48:49] op_sel_hi:[1,0,1]
    v_lshlrev_b32 v20, 16, v83
    v_and_b32 v21, 0xffff0000, v83
    v_pk_fma_f32 v[50:51], v[20:21], v[16:17], v[50:51] op_sel_hi:[1,0,1]
    v_lshlrev_b32 v18, 16, v84
    v_and_b32 v19, 0xffff0000, v84
    v_pk_fma_f32 v[52:53], v[18:19], v[16:17], v[52:53] op_sel_hi:[1,0,1]
    v_lshlrev_b32 v20, 16, v85
    v_and_b32 v21, 0xffff0000, v85
    v_pk_fma_f32 v[54:55], v[20:21], v[16:17], v[54:55] op_sel_hi:[1,0,1]
    v_lshlrev_b32 v18, 16, v86
    v_and_b32 v19, 0xffff0000, v86
    v_pk_fma_f32 v[56:57], v[18:19], v[16:17], v[56:57] op_sel_hi:[1,0,1]
    v_lshlrev_b32 v20, 16, v87
    v_and_b32 v21, 0xffff0000, v87
    v_pk_fma_f32 v[58:59], v[20:21], v[16:17], v[58:59] op_sel_hi:[1,0,1]
    buffer_load_dwordx4 v[76:79], v1, s[36:39], s75 offen offset:0 nt
    buffer_load_dwordx4 v[80:83], v1, s[36:39], s75 offen offset:128 nt
    buffer_load_dwordx4 v[84:87], v1, s[36:39], s75 offen offset:256 nt
    s_mov_b32 s60, s75
    s_add_u32 s75, s75, 24576
    s_waitcnt vmcnt(9)
    v_dot2_f32_bf16 v3, v88, v24, 0
    v_dot2_f32_bf16 v4, v94, v30, 0
    v_dot2_f32_bf16 v3, v89, v25, v3
    v_dot2_f32_bf16 v4, v95, v31, v4
    v_dot2_f32_bf16 v3, v90, v26, v3
    v_dot2_f32_bf16 v4, v96, v32, v4
    v_dot2_f32_bf16 v3, v91, v27, v3
    v_dot2_f32_bf16 v4, v97, v33, v4
    v_dot2_f32_bf16 v3, v92, v28, v3
    v_dot2_f32_bf16 v4, v98, v34, v4
    v_dot2_f32_bf16 v3, v93, v29, v3
    v_dot2_f32_bf16 v4, v99, v35, v4
    buffer_load_dwordx4 v[88:91], v1, s[32:35], s75 offen offset:0 nt
    buffer_load_dwordx4 v[92:95], v1, s[32:35], s75 offen offset:128 nt
    buffer_load_dwordx4 v[96:99], v1, s[32:35], s75 offen offset:256 nt
    v_add_f32 v3, v3, v4
    s_nop 1
    v_add_f32_dpp v3, v3, v3 quad_perm:[1,0,3,2] row_mask:0xf bank_mask:0xf
    s_nop 1
    v_add_f32_dpp v3, v3, v3 quad_perm:[2,3,0,1] row_mask:0xf bank_mask:0xf
    s_nop 1
    v_add_f32_dpp v3, v3, v3 row_half_mirror row_mask:0xf bank_mask:0xf
    v_cvt_pk_bf16_f32 v4, v3, v3
    v_lshlrev_b32 v4, 16, v4
    v_mul_f32 v4, 0x3d93cd3a, v4
    v_cvt_pk_bf16_f32 v4, v4, v4
    v_lshlrev_b32 v4, 16, v4
    v_max_f32 v5, v11, v4
    v_sub_f32 v6, v11, v5
    v_sub_f32 v7, v4, v5
    v_mul_f32 v6, 0x3fb8aa3b, v6
    v_mul_f32 v7, 0x3fb8aa3b, v7
    v_exp_f32 v14, v6
    v_exp_f32 v16, v7
    v_mov_b32 v11, v5
    v_fma_f32 v12, v12, v14, v16
    v_pk_mul_f32 v[36:37], v[36:37], v[14:15] op_sel_hi:[1,0]
    v_pk_mul_f32 v[38:39], v[38:39], v[14:15] op_sel_hi:[1,0]
    v_pk_mul_f32 v[40:41], v[40:41], v[14:15] op_sel_hi:[1,0]
    v_pk_mul_f32 v[42:43], v[42:43], v[14:15] op_sel_hi:[1,0]
    v_pk_mul_f32 v[44:45], v[44:45], v[14:15] op_sel_hi:[1,0]
    v_pk_mul_f32 v[46:47], v[46:47], v[14:15] op_sel_hi:[1,0]
    v_pk_mul_f32 v[48:49], v[48:49], v[14:15] op_sel_hi:[1,0]
    v_pk_mul_f32 v[50:51], v[50:51], v[14:15] op_sel_hi:[1,0]
    v_pk_mul_f32 v[52:53], v[52:53], v[14:15] op_sel_hi:[1,0]
    v_pk_mul_f32 v[54:55], v[54:55], v[14:15] op_sel_hi:[1,0]
    v_pk_mul_f32 v[56:57], v[56:57], v[14:15] op_sel_hi:[1,0]
    v_pk_mul_f32 v[58:59], v[58:59], v[14:15] op_sel_hi:[1,0]
    s_waitcnt vmcnt(9)
    v_lshlrev_b32 v18, 16, v100
    v_and_b32 v19, 0xffff0000, v100
    v_pk_fma_f32 v[36:37], v[18:19], v[16:17], v[36:37] op_sel_hi:[1,0,1]
    v_lshlrev_b32 v20, 16, v101
    v_and_b32 v21, 0xffff0000, v101
    v_pk_fma_f32 v[38:39], v[20:21], v[16:17], v[38:39] op_sel_hi:[1,0,1]
    v_lshlrev_b32 v18, 16, v102
    v_and_b32 v19, 0xffff0000, v102
    v_pk_fma_f32 v[40:41], v[18:19], v[16:17], v[40:41] op_sel_hi:[1,0,1]
    v_lshlrev_b32 v20, 16, v103
    v_and_b32 v21, 0xffff0000, v103
    v_pk_fma_f32 v[42:43], v[20:21], v[16:17], v[42:43] op_sel_hi:[1,0,1]
    v_lshlrev_b32 v18, 16, v104
    v_and_b32 v19, 0xffff0000, v104
    v_pk_fma_f32 v[44:45], v[18:19], v[16:17], v[44:45] op_sel_hi:[1,0,1]
    v_lshlrev_b32 v20, 16, v105
    v_and_b32 v21, 0xffff0000, v105
    v_pk_fma_f32 v[46:47], v[20:21], v[16:17], v[46:47] op_sel_hi:[1,0,1]
    v_lshlrev_b32 v18, 16, v106
    v_and_b32 v19, 0xffff0000, v106
    v_pk_fma_f32 v[48:49], v[18:19], v[16:17], v[48:49] op_sel_hi:[1,0,1]
    v_lshlrev_b32 v20, 16, v107
    v_and_b32 v21, 0xffff0000, v107
    v_pk_fma_f32 v[50:51], v[20:21], v[16:17], v[50:51] op_sel_hi:[1,0,1]
    v_lshlrev_b32 v18, 16, v108
    v_and_b32 v19, 0xffff0000, v108
    v_pk_fma_f32 v[52:53], v[18:19], v[16:17], v[52:53] op_sel_hi:[1,0,1]
    v_lshlrev_b32 v20, 16, v109
    v_and_b32 v21, 0xffff0000, v109
    v_pk_fma_f32 v[54:55], v[20:21], v[16:17], v[54:55] op_sel_hi:[1,0,1]
    v_lshlrev_b32 v18, 16, v110
    v_and_b32 v19, 0xffff0000, v110
    v_pk_fma_f32 v[56:57], v[18:19], v[16:17], v[56:57] op_sel_hi:[1,0,1]
    v_lshlrev_b32 v20, 16, v111
    v_and_b32 v21, 0xffff0000, v111
    v_pk_fma_f32 v[58:59], v[20:21], v[16:17], v[58:59] op_sel_hi:[1,0,1]
    buffer_load_dwordx4 v[100:103], v1, s[36:39], s75 offen offset:0 nt
    buffer_load_dwordx4 v[104:107], v1, s[36:39], s75 offen offset:128 nt
    buffer_load_dwordx4 v[108:111], v1, s[36:39], s75 offen offset:256 nt
    s_mov_b32 s61, s75
    s_add_u32 s75, s75, 24576
L_loopB:
    s_cmp_ge_u32 s60, 1572864
    s_cbranch_scc1 L_s_done
    s_waitcnt lgkmcnt(0)
    s_mov_b32 s64, s65
    s_mov_b32 s65, 2
    s_atomic_add s65, s[66:67], 0 glc
    s_waitcnt vmcnt(9)
    v_dot2_f32_bf16 v3, v64, v24, 0
    v_dot2_f32_bf16 v4, v70, v30, 0
    v_dot2_f32_bf16 v3, v65, v25, v3
    v_dot2_f32_bf16 v4, v71, v31, v4
    v_dot2_f32_bf16 v3, v66, v26, v3
    v_dot2_f32_bf16 v4, v72, v32, v4
    v_dot2_f32_bf16 v3, v67, v27, v3
    v_dot2_f32_bf16 v4, v73, v33, v4
    v_dot2_f32_bf16 v3, v68, v28, v3
    v_dot2_f32_bf16 v4, v74, v34, v4
    v_dot2_f32_bf16 v3, v69, v29, v3
    v_dot2_f32_bf16 v4, v75, v35, v4
    s_add_u32 s78, s64, 0
    s_min_u32 s78, s78, 96
    s_lshl_b32 s79, s78, 3
    s_add_u32 s79, s79, s68
    s_add_u32 s80, s78, 416
    s_cmp_lt_u32 s78, 16
    s_cselect_b32 s78, s79, s80
    s_mul_i32 s60, s78, 3072
    buffer_load_dwordx4 v[64:67], v1, s[32:35], s60 offen offset:0 nt
    buffer_load_dwordx4 v[68:71], v1, s[32:35], s60 offen offset:128 nt
    buffer_load_dwordx4 v[72:75], v1, s[32:35], s60 offen offset:256 nt
    v_add_f32 v3, v3, v4
    s_nop 1
    v_add_f32_dpp v3, v3, v3 quad_perm:[1,0,3,2] row_mask:0xf bank_mask:0xf
    s_nop 1
    v_add_f32_dpp v3, v3, v3 quad_perm:[2,3,0,1] row_mask:0xf bank_mask:0xf
    s_nop 1
    v_add_f32_dpp v3, v3, v3 row_half_mirror row_mask:0xf bank_mask:0xf
    v_cvt_pk_bf16_f32 v4, v3, v3
    v_lshlrev_b32 v4, 16, v4
    v_mul_f32 v4, 0x3d93cd3a, v4
    v_cvt_pk_bf16_f32 v4, v4, v4
    v_lshlrev_b32 v4, 16, v4
    v_max_f32 v5, v11, v4
    v_sub_f32 v6, v11, v5
    v_sub_f32 v7, v4, v5
    v_mul_f32 v6, 0x3fb8aa3b, v6
    v_mul_f32 v7, 0x3fb8aa3b, v7
    v_exp_f32 v14, v6
    v_exp_f32 v16, v7
    v_mov_b32 v11, v5
    v_fma_f32 v12, v12, v14, v16
    v_pk_mul_f32 v[36:37], v[36:37], v[14:15] op_sel_hi:[1,0]
    v_pk_mul_f32 v[38:39], v[38:39], v[14:15] op_sel_hi:[1,0]
    v_pk_mul_f32 v[40:41], v[40:41], v[14:15] op_sel_hi:[1,0]
    v_pk_mul_f32 v[42:43], v[42:43], v[14:15] op_sel_hi:[1,0]
    v_pk_mul_f32 v[44:45], v[44:45], v[14:15] op_sel_hi:[1,0]
    v_pk_mul_f32 v[46:47], v[46:47], v[14:15] op_sel_hi:[1,0]
    v_pk_mul_f32 v[48:49], v[48:49], v[14:15] op_sel_hi:[1,0]
    v_pk_mul_f32 v[50:51], v[50:51], v[14:15] op_sel_hi:[1,0]
    v_pk_mul_f32 v[52:53], v[52:53], v[14:15] op_sel_hi:[1,0]
    v_pk_mul_f32 v[54:55], v[54:55], v[14:15] op_sel_hi:[1,0]
    v_pk_mul_f32 v[56:57], v[56:57], v[14:15] op_sel_hi:[1,0]
    v_pk_mul_f32 v[58:59], v[58:59], v[14:15] op_sel_hi:[1,0]
    s_waitcnt vmcnt(9)
    v_lshlrev_b32 v18, 16, v76
    v_and_b32 v19, 0xffff0000, v76
    v_pk_fma_f32 v[36:37], v[18:19], v[16:17], v[36:37] op_sel_hi:[1,0,1]
    v_lshlrev_b32 v20, 16, v77
    v_and_b32 v21, 0xffff0000, v77
    v_pk_fma_f32 v[38:39], v[20:21], v[16:17], v[38:39] op_sel_hi:[1,0,1]
    v_lshlrev_b32 v18, 16, v78
    v_and_b32 v19, 0xffff0000, v78
    v_pk_fma_f32 v[40:41], v[18:19], v[16:17], v[40:41] op_sel_hi:[1,0,1]
    v_lshlrev_b32 v20, 16, v79
    v_and_b32 v21, 0xffff0000, v79
    v_pk_fma_f32 v[42:43], v[20:21], v[16:17], v[42:43] op_sel_hi:[1,0,1]
    v_lshlrev_b32 v18, 16, v80
    v_and_b32 v19, 0xffff0000, v80
    v_pk_fma_f32 v[44:45], v[18:19], v[16:17], v[44:45] op_sel_hi:[1,0,1]
    v_lshlrev_b32 v20, 16, v81
    v_and_b32 v21, 0xffff0000, v81
    v_pk_fma_f32 v[46:47], v[20:21], v[16:17], v[46:47] op_sel_hi:[1,0,1]
    v_lshlrev_b32 v18, 16, v82
    v_and_b32 v19, 0xffff0000, v82
    v_pk_fma_f32 v[48:49], v[18:19], v[16:17], v[48:49] op_sel_hi:[1,0,1]
    v_lshlrev_b32 v20, 16, v83
    v_and_b32 v21, 0xffff0000, v83
    v_pk_fma_f32 v[50:51], v[20:21], v[16:17], v[50:51] op_sel_hi:[1,0,1]
    v_lshlrev_b32 v18, 16, v84
    v_and_b32 v19, 0xffff0000, v84
    v_pk_fma_f32 v[52:53], v[18:19], v[16:17], v[52:53] op_sel_hi:[1,0,1]
    v_lshlrev_b32 v20, 16, v85
    v_and_b32 v21, 0xffff0000, v85
    v_pk_fma_f32 v[54:55], v[20:21], v[16:17], v[54:55] op_sel_hi:[1,0,1]
    v_lshlrev_b32 v18, 16, v86
    v_and_b32 v19, 0xffff0000, v86
    v_pk_fma_f32 v[56:57], v[18:19], v[16:17], v[56:57] op_sel_hi:[1,0,1]
    v_lshlrev_b32 v20, 16, v87
    v_and_b32 v21, 0xffff0000, v87
    v_pk_fma_f32 v[58:59], v[20:21], v[16:17], v[58:59] op_sel_hi:[1,0,1]
    buffer_load_dwordx4 v[76:79], v1, s[36:39], s60 offen offset:0 nt
    buffer_load_dwordx4 v[80:83], v1, s[36:39], s60 offen offset:128 nt
    buffer_load_dwordx4 v[84:87], v1, s[36:39], s60 offen offset:256 nt
    s_cmp_ge_u32 s61, 1572864
    s_cbranch_scc1 L_s_done
    s_waitcnt vmcnt(9)
    v_dot2_f32_bf16 v3, v88, v24, 0
    v_dot2_f32_bf16 v4, v94, v30, 0
    v_dot2_f32_bf16 v3, v89, v25, v3
    v_dot2_f32_bf16 v4, v95, v31, v4
    v_dot2_f32_bf16 v3, v90, v26, v3
    v_dot2_f32_bf16 v4, v96, v32, v4
    v_dot2_f32_bf16 v3, v91, v27, v3
    v_dot2_f32_bf16 v4, v97, v33, v4
    v_dot2_f32_bf16 v3, v92, v28, v3
    v_dot2_f32_bf16 v4, v98, v34, v4
    v_dot2_f32_bf16 v3, v93, v29, v3
    v_dot2_f32_bf16 v4, v99, v35, v4
    s_add_u32 s78, s64, 1
    s_min_u32 s78, s78, 96
    s_lshl_b32 s79, s78, 3
    s_add_u32 s79, s79, s68
    s_add_u32 s80, s78, 416
    s_cmp_lt_u32 s78, 16
    s_cselect_b32 s78, s79, s80
    s_mul_i32 s61, s78, 3072
    buffer_load_dwordx4 v[88:91], v1, s[32:35], s61 offen offset:0 nt
    buffer_load_dwordx4 v[92:95], v1, s[32:35], s61 offen offset:128 nt
    buffer_load_dwordx4 v[96:99], v1, s[32:35], s61 offen offset:256 nt
    v_add_f32 v3, v3, v4
    s_nop 1
    v_add_f32_dpp v3, v3, v3 quad_perm:[1,0,3,2] row_mask:0xf bank_mask:0xf
    s_nop 1
    v_add_f32_dpp v3, v3, v3 quad_perm:[2,3,0,1] row_mask:0xf bank_mask:0xf
    s_nop 1
    v_add_f32_dpp v3, v3, v3 row_half_mirror row_mask:0xf bank_mask:0xf
    v_cvt_pk_bf16_f32 v4, v3, v3
    v_lshlrev_b32 v4, 16, v4
    v_mul_f32 v4, 0x3d93cd3a, v4
    v_cvt_pk_bf16_f32 v4, v4, v4
    v_lshlrev_b32 v4, 16, v4
    v_max_f32 v5, v11, v4
    v_sub_f32 v6, v11, v5
    v_sub_f32 v7, v4, v5
    v_mul_f32 v6, 0x3fb8aa3b, v6
    v_mul_f32 v7, 0x3fb8aa3b, v7
    v_exp_f32 v14, v6
    v_exp_f32 v16, v7
    v_mov_b32 v11, v5
    v_fma_f32 v12, v12, v14, v16
    v_pk_mul_f32 v[36:37], v[36:37], v[14:15] op_sel_hi:[1,0]
    v_pk_mul_f32 v[38:39], v[38:39], v[14:15] op_sel_hi:[1,0]
    v_pk_mul_f32 v[40:41], v[40:41], v[14:15] op_sel_hi:[1,0]
    v_pk_mul_f32 v[42:43], v[42:43], v[14:15] op_sel_hi:[1,0]
    v_pk_mul_f32 v[44:45], v[44:45], v[14:15] op_sel_hi:[1,0]
    v_pk_mul_f32 v[46:47], v[46:47], v[14:15] op_sel_hi:[1,0]
    v_pk_mul_f32 v[48:49], v[48:49], v[14:15] op_sel_hi:[1,0]
    v_pk_mul_f32 v[50:51], v[50:51], v[14:15] op_sel_hi:[1,0]
    v_pk_mul_f32 v[52:53], v[52:53], v[14:15] op_sel_hi:[1,0]
    v_pk_mul_f32 v[54:55], v[54:55], v[14:15] op_sel_hi:[1,0]
    v_pk_mul_f32 v[56:57], v[56:57], v[14:15] op_sel_hi:[1,0]
    v_pk_mul_f32 v[58:59], v[58:59], v[14:15] op_sel_hi:[1,0]
    s_waitcnt vmcnt(9)
    v_lshlrev_b32 v18, 16, v100
    v_and_b32 v19, 0xffff0000, v100
    v_pk_fma_f32 v[36:37], v[18:19], v[16:17], v[36:37] op_sel_hi:[1,0,1]
    v_lshlrev_b32 v20, 16, v101
    v_and_b32 v21, 0xffff0000, v101
    v_pk_fma_f32 v[38:39], v[20:21], v[16:17], v[38:39] op_sel_hi:[1,0,1]
    v_lshlrev_b32 v18, 16, v102
    v_and_b32 v19, 0xffff0000, v102
    v_pk_fma_f32 v[40:41], v[18:19], v[16:17], v[40:41] op_sel_hi:[1,0,1]
    v_lshlrev_b32 v20, 16, v103
    v_and_b32 v21, 0xffff0000, v103
    v_pk_fma_f32 v[42:43], v[20:21], v[16:17], v[42:43] op_sel_hi:[1,0,1]
    v_lshlrev_b32 v18, 16, v104
    v_and_b32 v19, 0xffff0000, v104
    v_pk_fma_f32 v[44:45], v[18:19], v[16:17], v[44:45] op_sel_hi:[1,0,1]
    v_lshlrev_b32 v20, 16, v105
    v_and_b32 v21, 0xffff0000, v105
    v_pk_fma_f32 v[46:47], v[20:21], v[16:17], v[46:47] op_sel_hi:[1,0,1]
    v_lshlrev_b32 v18, 16, v106
    v_and_b32 v19, 0xffff0000, v106
    v_pk_fma_f32 v[48:49], v[18:19], v[16:17], v[48:49] op_sel_hi:[1,0,1]
    v_lshlrev_b32 v20, 16, v107
    v_and_b32 v21, 0xffff0000, v107
    v_pk_fma_f32 v[50:51], v[20:21], v[16:17], v[50:51] op_sel_hi:[1,0,1]
    v_lshlrev_b32 v18, 16, v108
    v_and_b32 v19, 0xffff0000, v108
    v_pk_fma_f32 v[52:53], v[18:19], v[16:17], v[52:53] op_sel_hi:[1,0,1]
    v_lshlrev_b32 v20, 16, v109
    v_and_b32 v21, 0xffff0000, v109
    v_pk_fma_f32 v[54:55], v[20:21], v[16:17], v[54:55] op_sel_hi:[1,0,1]
    v_lshlrev_b32 v18, 16, v110
    v_and_b32 v19, 0xffff0000, v110
    v_pk_fma_f32 v[56:57], v[18:19], v[16:17], v[56:57] op_sel_hi:[1,0,1]
    v_lshlrev_b32 v20, 16, v111
    v_and_b32 v21, 0xffff0000, v111
    v_pk_fma_f32 v[58:59], v[20:21], v[16:17], v[58:59] op_sel_hi:[1,0,1]
    buffer_load_dwordx4 v[100:103], v1, s[36:39], s61 offen offset:0 nt
    buffer_load_dwordx4 v[104:107], v1, s[36:39], s61 offen offset:128 nt
    buffer_load_dwordx4 v[108:111], v1, s[36:39], s61 offen offset:256 nt
    s_branch L_loopB
L_s_done:
    s_mov_b64 exec, -1
    v_max_f32_dpp v3, v11, v11 row_ror:8 row_mask:0xf bank_mask:0xf
    v_mov_b32 v4, v3
    s_nop 1
    v_permlane16_swap_b32 v3, v4
    v_max_f32 v3, v3, v4
    v_mov_b32 v4, v3
    s_nop 1
    v_permlane32_swap_b32 v3, v4
    v_max_f32 v3, v3, v4
    v_sub_f32 v4, v11, v3
    v_mul_f32 v4, 0x3fb8aa3b, v4
    v_exp_f32 v14, v4
    s_nop 0
    v_mul_f32 v12, v12, v14
    v_pk_mul_f32 v[36:37], v[36:37], v[14:15] op_sel_hi:[1,0]
    v_pk_mul_f32 v[38:39], v[38:39], v[14:15] op_sel_hi:[1,0]
    v_pk_mul_f32 v[40:41], v[40:41], v[14:15] op_sel_hi:[1,0]
    v_pk_mul_f32 v[42:43], v[42:43], v[14:15] op_sel_hi:[1,0]
    v_pk_mul_f32 v[44:45], v[44:45], v[14:15] op_sel_hi:[1,0]
    v_pk_mul_f32 v[46:47], v[46:47], v[14:15] op_sel_hi:[1,0]
    v_pk_mul_f32 v[48:49], v[48:49], v[14:15] op_sel_hi:[1,0]
    v_pk_mul_f32 v[50:51], v[50:51], v[14:15] op_sel_hi:[1,0]
    v_pk_mul_f32 v[52:53], v[52:53], v[14:15] op_sel_hi:[1,0]
    v_pk_mul_f32 v[54:55], v[54:55], v[14:15] op_sel_hi:[1,0]
    v_pk_mul_f32 v[56:57], v[56:57], v[14:15] op_sel_hi:[1,0]
    v_pk_mul_f32 v[58:59], v[58:59], v[14:15] op_sel_hi:[1,0]
    v_add_f32_dpp v12, v12, v12 row_ror:8 row_mask:0xf bank_mask:0xf
    v_mov_b32 v4, v12
    s_nop 1
    v_permlane16_swap_b32 v12, v4
    v_add_f32 v12, v12, v4
    v_mov_b32 v4, v12
    s_nop 1
    v_permlane32_swap_b32 v12, v4
    v_add_f32 v12, v12, v4
    v_permlane32_swap_b32 v36, v48
    v_permlane32_swap_b32 v37, v49
    v_permlane32_swap_b32 v38, v50
    v_permlane32_swap_b32 v39, v51
    v_permlane32_swap_b32 v40, v52
    v_permlane32_swap_b32 v41, v53
    v_permlane32_swap_b32 v42, v54
    v_permlane32_swap_b32 v43, v55
    v_permlane32_swap_b32 v44, v56
    v_permlane32_swap_b32 v45, v57
    v_permlane32_swap_b32 v46, v58
    v_permlane32_swap_b32 v47, v59
    v_add_f32 v36, v36, v48
    v_add_f32 v37, v37, v49
    v_add_f32 v38, v38, v50
    v_add_f32 v39, v39, v51
    v_add_f32 v40, v40, v52
    v_add_f32 v41, v41, v53
    v_add_f32 v42, v42, v54
    v_add_f32 v43, v43, v55
    v_add_f32 v44, v44, v56
    v_add_f32 v45, v45, v57
    v_add_f32 v46, v46, v58
    v_add_f32 v47, v47, v59
    v_permlane16_swap_b32 v36, v42
    v_permlane16_swap_b32 v37, v43
    v_permlane16_swap_b32 v38, v44
    v_permlane16_swap_b32 v39, v45
    v_permlane16_swap_b32 v40, v46
    v_permlane16_swap_b32 v41, v47
    v_add_f32 v36, v36, v42
    v_add_f32 v37, v37, v43
    v_add_f32 v38, v38, v44
    v_add_f32 v39, v39, v45
    v_add_f32 v40, v40, v46
    v_add_f32 v41, v41, v47
    v_and_b32 v4, 8, v0
    v_cmp_ne_u32 vcc, 0, v4
    s_nop 1
    v_cndmask_b32 v18, v39, v36, vcc
    v_cndmask_b32 v24, v36, v39, vcc
    v_cndmask_b32 v19, v40, v37, vcc
    v_cndmask_b32 v25, v37, v40, vcc
    v_cndmask_b32 v20, v41, v38, vcc
    v_cndmask_b32 v26, v38, v41, vcc
    v_mov_b32 v27, v8
    v_add_f32_dpp v24, v18, v24 row_ror:8 row_mask:0xf bank_mask:0xf
    v_add_f32_dpp v25, v19, v25 row_ror:8 row_mask:0xf bank_mask:0xf
    v_add_f32_dpp v26, v20, v26 row_ror:8 row_mask:0xf bank_mask:0xf
    v_lshlrev_b32 v4, 4, v0
    buffer_store_dwordx4 v[24:27], v4, s[28:31], s83 offen sc1
    v_mov_b32 v28, v3
    v_mov_b32 v29, v12
    v_mov_b32 v30, v8
    v_mov_b32 v31, v9
    s_mov_b64 exec, 1
    buffer_store_dwordx4 v[28:31], v4, s[28:31], s83 offen offset:1024 sc1
    s_mov_b64 exec, -1
    s_barrier
    s_endpgm
L_helper:
    s_setprio 2
    v_mov_b32 v1, 0
    v_mov_b32 v2, 1
    v_lshlrev_b32 v3, 2, v0
    v_lshlrev_b32 v4, 4, v0
    v_mov_b32 v128, 0
    v_mov_b32 v129, 0
    v_mov_b32 v130, 0
    v_mov_b32 v131, 0
    ds_write_b128 v1, v[128:131] offset:63488
    ds_write_b64 v1, v[128:129] offset:63504
    ds_write_b32 v1, v128 offset:63520
    s_cmp_lt_u32 s73, 6
    s_cbranch_scc1 L_q_consumer
    v_add_u32 v26, 0, v0
    v_mul_u32_u24 v27, 2731, v26
    v_lshrrev_b32 v27, 16, v27
    v_mul_u32_u24 v28, 24, v27
    v_sub_u32 v26, v26, v28
    v_mul_u32_u24 v27, 12288, v27
    v_lshl_add_u32 v5, v26, 4, v27
    v_add_u32 v26, 64, v0
    v_mul_u32_u24 v27, 2731, v26
    v_lshrrev_b32 v27, 16, v27
    v_mul_u32_u24 v28, 24, v27
    v_sub_u32 v26, v26, v28
    v_mul_u32_u24 v27, 12288, v27
    v_lshl_add_u32 v6, v26, 4, v27
    v_add_u32 v26, 128, v0
    v_mul_u32_u24 v27, 2731, v26
    v_lshrrev_b32 v27, 16, v27
    v_mul_u32_u24 v28, 24, v27
    v_sub_u32 v26, v26, v28
    v_mul_u32_u24 v27, 12288, v27
    v_lshl_add_u32 v7, v26, 4, v27
    s_mul_i32 s75, s3, 1280
    s_and_b32 s33, s73, 1
    s_mul_i32 s76, s33, 3932160
    s_mul_i32 s77, s72, 384
    s_add_u32 s76, s76, s77
    s_mul_i32 s77, s3, 98304
    s_add_u32 s76, s76, s77
    s_mul_i32 s32, s3, 3072
    s_add_u32 s83, s32, 63552
    s_waitcnt lgkmcnt(0)
    s_mov_b32 s40, s4
    s_mov_b32 s41, s5
    s_mov_b32 s42, 5120
    s_mov_b32 s43, 0x20000
    s_mov_b32 s44, s10
    s_mov_b32 s45, s11
    s_mov_b32 s46, 7864320
    s_mov_b32 s47, 0x20000
    buffer_load_dword v8, v3, s[40:43], s75 offen offset:0
    buffer_load_dword v9, v3, s[40:43], s75 offen offset:256
    buffer_load_dword v10, v3, s[40:43], s75 offen offset:512
    buffer_load_dword v11, v3, s[40:43], s75 offen offset:768
    buffer_load_dword v12, v3, s[40:43], s75 offen offset:1024
    s_add_u32 m0, s32, 0
    s_nop 0
    buffer_load_dwordx4 v5, s[44:47], s76 offen nt lds
    s_add_u32 m0, s32, 1024
    s_nop 0
    buffer_load_dwordx4 v6, s[44:47], s76 offen nt lds
    s_add_u32 m0, s32, 2048
    s_nop 0
    buffer_load_dwordx4 v7, s[44:47], s76 offen nt lds
    s_add_u32 s76, s76, 393216
    s_add_u32 m0, s32, 12288
    s_nop 0
    buffer_load_dwordx4 v5, s[44:47], s76 offen nt lds
    s_add_u32 m0, s32, 13312
    s_nop 0
    buffer_load_dwordx4 v6, s[44:47], s76 offen nt lds
    s_add_u32 m0, s32, 14336
    s_nop 0
    buffer_load_dwordx4 v7, s[44:47], s76 offen nt lds
    s_add_u32 s76, s76, 393216
    s_add_u32 m0, s32, 24576
    s_nop 0
    buffer_load_dwordx4 v5, s[44:47], s76 offen nt lds
    s_add_u32 m0, s32, 25600
    s_nop 0
    buffer_load_dwordx4 v6, s[44:47], s76 offen nt lds
    s_add_u32 m0, s32, 26624
    s_nop 0
    buffer_load_dwordx4 v7, s[44:47], s76 offen nt lds
    s_add_u32 s76, s76, 393216
    s_add_u32 m0, s32, 36864
    s_nop 0
    buffer_load_dwordx4 v5, s[44:47], s76 offen nt lds
    s_add_u32 m0, s32, 37888
    s_nop 0
    buffer_load_dwordx4 v6, s[44:47], s76 offen nt lds
    s_add_u32 m0, s32, 38912
    s_nop 0
    buffer_load_dwordx4 v7, s[44:47], s76 offen nt lds
    s_add_u32 s76, s76, 393216
    s_add_u32 m0, s83, 0
    s_nop 0
    buffer_load_dwordx4 v5, s[44:47], s76 offen nt lds
    s_add_u32 m0, s83, 1024
    s_nop 0
    buffer_load_dwordx4 v6, s[44:47], s76 offen nt lds
    s_add_u32 m0, s83, 2048
    s_nop 0
    buffer_load_dwordx4 v7, s[44:47], s76 offen nt lds
    s_add_u32 s76, s76, 393216
    s_add_u32 m0, s83, 12288
    s_nop 0
    buffer_load_dwordx4 v5, s[44:47], s76 offen nt lds
    s_add_u32 m0, s83, 13312
    s_nop 0
    buffer_load_dwordx4 v6, s[44:47], s76 offen nt lds
    s_add_u32 m0, s83, 14336
    s_nop 0
    buffer_load_dwordx4 v7, s[44:47], s76 offen nt lds
    s_add_u32 s76, s76, 393216
    s_add_u32 m0, s83, 24576
    s_nop 0
    buffer_load_dwordx4 v5, s[44:47], s76 offen nt lds
    s_add_u32 m0, s83, 25600
    s_nop 0
    buffer_load_dwordx4 v6, s[44:47], s76 offen nt lds
    s_add_u32 m0, s83, 26624
    s_nop 0
    buffer_load_dwordx4 v7, s[44:47], s76 offen nt lds
    s_add_u32 s76, s76, 393216
    s_add_u32 m0, s83, 36864
    s_nop 0
    buffer_load_dwordx4 v5, s[44:47], s76 offen nt lds
    s_add_u32 m0, s83, 37888
    s_nop 0
    buffer_load_dwordx4 v6, s[44:47], s76 offen nt lds
    s_add_u32 m0, s83, 38912
    s_nop 0
    buffer_load_dwordx4 v7, s[44:47], s76 offen nt lds
    s_add_u32 s76, s76, 393216
    s_add_u32 m0, s83, 49152
    s_nop 0
    buffer_load_dwordx4 v5, s[44:47], s76 offen nt lds
    s_add_u32 m0, s83, 50176
    s_nop 0
    buffer_load_dwordx4 v6, s[44:47], s76 offen nt lds
    s_add_u32 m0, s83, 51200
    s_nop 0
    buffer_load_dwordx4 v7, s[44:47], s76 offen nt lds
    s_add_u32 s76, s76, 393216
    s_add_u32 m0, s83, 61440
    s_nop 0
    buffer_load_dwordx4 v5, s[44:47], s76 offen nt lds
    s_add_u32 m0, s83, 62464
    s_nop 0
    buffer_load_dwordx4 v6, s[44:47], s76 offen nt lds
    s_add_u32 m0, s83, 63488
    s_nop 0
    buffer_load_dwordx4 v7, s[44:47], s76 offen nt lds
    s_add_u32 s76, s76, 393216
    s_mov_b32 s48, s24
    s_mov_b32 s49, s25
    s_mov_b32 s50, 256
    s_mov_b32 s51, 0x20000
    s_mov_b32 s28, s26
    s_mov_b32 s29, s27
    s_mov_b32 s30, 16777216
    s_mov_b32 s31, 0x20000
    s_lshl_b32 s76, s3, 5
    s_add_u32 s76, s76, s72
    s_lshl_b32 s76, s76, 8
    s_add_u32 s76, s76, 6356992
    s_cmp_eq_u32 s33, 0
    s_cselect_b32 s76, s76, 2147483648
    s_mov_b64 exec, 1
    buffer_store_dword v1, v1, s[28:31], s76 offen sc1
    s_mov_b64 exec, -1
    s_barrier
    s_waitcnt vmcnt(31)
    s_mov_b32 s80, 0x44200000
    v_lshlrev_b32 v16, 16, v8
    v_and_b32 v17, 0xffff0000, v8
    v_lshlrev_b32 v18, 16, v9
    v_and_b32 v19, 0xffff0000, v9
    v_lshlrev_b32 v20, 16, v10
    v_and_b32 v21, 0xffff0000, v10
    v_lshlrev_b32 v22, 16, v11
    v_and_b32 v23, 0xffff0000, v11
    v_lshlrev_b32 v24, 16, v12
    v_and_b32 v25, 0xffff0000, v12
    v_add_f32 v26, v16, v17
    v_add_f32 v27, v18, v19
    v_add_f32 v28, v20, v21
    v_add_f32 v29, v22, v23
    v_add_f32 v30, v24, v25
    v_add_f32 v26, v26, v27
    v_add_f32 v28, v28, v29
    v_add_f32 v26, v26, v30
    v_add_f32 v26, v26, v28
    v_readfirstlane_b32 s79, v16
    s_nop 1
    v_subrev_f32 v28, s79, v16
    v_mul_f32 v27, v28, v28
    v_subrev_f32 v29, s79, v17
    v_fmac_f32 v27, v29, v29
    v_subrev_f32 v28, s79, v18
    v_fmac_f32 v27, v28, v28
    v_subrev_f32 v29, s79, v19
    v_fmac_f32 v27, v29, v29
    v_subrev_f32 v28, s79, v20
    v_fmac_f32 v27, v28, v28
    v_subrev_f32 v29, s79, v21
    v_fmac_f32 v27, v29, v29
    v_subrev_f32 v28, s79, v22
    v_fmac_f32 v27, v28, v28
    v_subrev_f32 v29, s79, v23
    v_fmac_f32 v27, v29, v29
    v_subrev_f32 v28, s79, v24
    v_fmac_f32 v27, v28, v28
    v_subrev_f32 v29, s79, v25
    v_fmac_f32 v27, v29, v29
    v_add_f32_dpp v26, v26, v26 quad_perm:[1,0,3,2] row_mask:0xf bank_mask:0xf
    s_nop 0
    v_add_f32_dpp v27, v27, v27 quad_perm:[1,0,3,2] row_mask:0xf bank_mask:0xf
    v_add_f32_dpp v26, v26, v26 quad_perm:[2,3,0,1] row_mask:0xf bank_mask:0xf
    s_nop 0
    v_add_f32_dpp v27, v27, v27 quad_perm:[2,3,0,1] row_mask:0xf bank_mask:0xf
    v_add_f32_dpp v26, v26, v26 row_ror:4 row_mask:0xf bank_mask:0xf
    s_nop 0
    v_add_f32_dpp v27, v27, v27 row_ror:4 row_mask:0xf bank_mask:0xf
    v_add_f32_dpp v26, v26, v26 row_ror:8 row_mask:0xf bank_mask:0xf
    s_nop 0
    v_add_f32_dpp v27, v27, v27 row_ror:8 row_mask:0xf bank_mask:0xf
    v_mov_b32 v28, v26
    v_mov_b32 v29, v27
    s_nop 0
    v_permlane16_swap_b32 v26, v28
    v_permlane16_swap_b32 v27, v29
    v_add_f32 v26, v26, v28
    v_add_f32 v27, v27, v29
    v_mov_b32 v28, v26
    v_mov_b32 v29, v27
    s_nop 0
    v_permlane32_swap_b32 v26, v28
    v_permlane32_swap_b32 v27, v29
    v_add_f32 v26, v26, v28
    v_add_f32 v27, v27, v29
    v_mul_f32 v28, 0x3acccccd, v26
    v_fma_f32 v29, -v28, s80, v26
    v_mul_f32 v29, 0x3acccccd, v29
    v_add_f32 v26, v28, v29
    v_mul_f32 v30, 0x3acccccd, v27
    v_fma_f32 v31, -v30, s80, v27
    v_mul_f32 v31, 0x3acccccd, v31
    v_add_f32 v27, v30, v31
    v_subrev_f32 v28, s79, v26
    v_fma_f32 v27, -v28, v28, v27
    v_max_f32 v27, 0, v27
    v_cvt_pk_bf16_f32 v26, v26, v26
    v_lshlrev_b32 v26, 16, v26
    v_cvt_pk_bf16_f32 v27, v27, v27
    v_lshlrev_b32 v27, 16, v27
    v_add_f32 v27, 0x3727c5ac, v27
    v_cvt_pk_bf16_f32 v27, v27, v27
    v_lshlrev_b32 v27, 16, v27
    v_sqrt_f32 v27, v27
    s_nop 0
    v_cvt_pk_bf16_f32 v27, v27, v27
    v_lshlrev_b32 v27, 16, v27
    v_rcp_f32 v28, v27
    v_sub_f32 v16, v16, v26
    v_sub_f32 v17, v17, v26
    v_cvt_pk_bf16_f32 v17, v16, v17
    v_lshlrev_b32 v16, 16, v17
    v_and_b32 v17, 0xffff0000, v17
    v_mul_f32 v29, v16, v28
    v_mul_f32 v30, v17, v28
    v_fma_f32 v16, -v29, v27, v16
    v_fma_f32 v17, -v30, v27, v17
    v_fmac_f32 v29, v16, v28
    v_fmac_f32 v30, v17, v28
    v_cvt_pk_bf16_f32 v8, v29, v30
    v_sub_f32 v18, v18, v26
    v_sub_f32 v19, v19, v26
    v_cvt_pk_bf16_f32 v19, v18, v19
    v_lshlrev_b32 v18, 16, v19
    v_and_b32 v19, 0xffff0000, v19
    v_mul_f32 v29, v18, v28
    v_mul_f32 v30, v19, v28
    v_fma_f32 v18, -v29, v27, v18
    v_fma_f32 v19, -v30, v27, v19
    v_fmac_f32 v29, v18, v28
    v_fmac_f32 v30, v19, v28
    v_cvt_pk_bf16_f32 v9, v29, v30
    v_sub_f32 v20, v20, v26
    v_sub_f32 v21, v21, v26
    v_cvt_pk_bf16_f32 v21, v20, v21
    v_lshlrev_b32 v20, 16, v21
    v_and_b32 v21, 0xffff0000, v21
    v_mul_f32 v29, v20, v28
    v_mul_f32 v30, v21, v28
    v_fma_f32 v20, -v29, v27, v20
    v_fma_f32 v21, -v30, v27, v21
    v_fmac_f32 v29, v20, v28
    v_fmac_f32 v30, v21, v28
    v_cvt_pk_bf16_f32 v10, v29, v30
    v_sub_f32 v22, v22, v26
    v_sub_f32 v23, v23, v26
    v_cvt_pk_bf16_f32 v23, v22, v23
    v_lshlrev_b32 v22, 16, v23
    v_and_b32 v23, 0xffff0000, v23
    v_mul_f32 v29, v22, v28
    v_mul_f32 v30, v23, v28
    v_fma_f32 v22, -v29, v27, v22
    v_fma_f32 v23, -v30, v27, v23
    v_fmac_f32 v29, v22, v28
    v_fmac_f32 v30, v23, v28
    v_cvt_pk_bf16_f32 v11, v29, v30
    v_sub_f32 v24, v24, v26
    v_sub_f32 v25, v25, v26
    v_cvt_pk_bf16_f32 v25, v24, v25
    v_lshlrev_b32 v24, 16, v25
    v_and_b32 v25, 0xffff0000, v25
    v_mul_f32 v29, v24, v28
    v_mul_f32 v30, v25, v28
    v_fma_f32 v24, -v29, v27, v24
    v_fma_f32 v25, -v30, v27, v25
    v_fmac_f32 v29, v24, v28
    v_fmac_f32 v30, v25, v28
    v_cvt_pk_bf16_f32 v12, v29, v30
    v_add_u32 v5, s75, v3
    ds_write_b32 v5, v8 offset:49152
    ds_write_b32 v5, v9 offset:49408
    ds_write_b32 v5, v10 offset:49664
    ds_write_b32 v5, v11 offset:49920
    ds_write_b32 v5, v12 offset:50176
    buffer_load_dwordx2 v[14:15], v1, s[48:51], 0 offen sc1
    v_lshrrev_b32 v26, 4, v0
    v_and_b32 v27, 3, v0
    v_mul_u32_u24 v5, 1280, v27
    v_lshl_add_u32 v5, v26, 4, v5
    s_mul_i32 s77, s33, 640
    v_add_u32 v5, s77, v5
    v_lshlrev_b32 v26, 3, v26
    v_bfe_u32 v28, v0, 2, 2
    v_add_u32 v26, v26, v28
    v_mul_u32_u24 v6, 384, v26
    v_lshl_add_u32 v6, v27, 3, v6
    s_mul_i32 s77, s3, 96
    v_add_u32 v30, s77, v6
    s_add_u32 s77, s77, 63552
    v_add_u32 v6, s77, v6
    v_add_u32 v31, 36864, v6
    s_mul_i32 s77, s3, 192
    v_add_u32 v7, s77, v3
    s_waitcnt vmcnt(2) lgkmcnt(0)
    s_mov_b64 exec, 1
    ds_add_u32 v1, v2 offset:63488
    s_mov_b64 exec, -1
    s_mov_b32 s81, 8000000
L_lw_5:
    ds_read_b32 v26, v1 offset:63488
    s_waitcnt lgkmcnt(0)
    v_readfirstlane_b32 s79, v26
    s_nop 0
    s_cmp_ge_u32 s79, 4
    s_cbranch_scc1 L_lwd_6
    s_sleep 1
    s_sub_u32 s81, s81, 1
    s_cmp_lg_u32 s81, 0
    s_cbranch_scc1 L_lw_5
L_lwd_6:
    ds_read_b128 v[32:35], v5 offset:49152
    ds_read_b128 v[36:39], v5 offset:49216
    ds_read_b128 v[40:43], v5 offset:49280
    ds_read_b128 v[44:47], v5 offset:49344
    ds_read_b128 v[48:51], v5 offset:49408
    ds_read_b128 v[52:55], v5 offset:49472
    ds_read_b128 v[56:59], v5 offset:49536
    ds_read_b128 v[60:63], v5 offset:49600
    ds_read_b128 v[64:67], v5 offset:49664
    ds_read_b128 v[68:71], v5 offset:49728
    ds_read_b64_tr_b16 v[160:161], v30 offset:0
    ds_read_b64_tr_b16 v[162:163], v30 offset:1536
    ds_read_b64_tr_b16 v[164:165], v30 offset:32
    ds_read_b64_tr_b16 v[166:167], v30 offset:1568
    ds_read_b64_tr_b16 v[168:169], v30 offset:64
    ds_read_b64_tr_b16 v[170:171], v30 offset:1600
    ds_read_b64_tr_b16 v[172:173], v30 offset:12288
    ds_read_b64_tr_b16 v[174:175], v30 offset:13824
    ds_read_b64_tr_b16 v[176:177], v30 offset:12320
    ds_read_b64_tr_b16 v[178:179], v30 offset:13856
    ds_read_b64_tr_b16 v[180:181], v30 offset:12352
    ds_read_b64_tr_b16 v[182:183], v30 offset:13888
    ds_read_b64_tr_b16 v[184:185], v30 offset:24576
    ds_read_b64_tr_b16 v[186:187], v30 offset:26112
    ds_read_b64_tr_b16 v[188:189], v30 offset:24608
    ds_read_b64_tr_b16 v[190:191], v30 offset:26144
    ds_read_b64_tr_b16 v[192:193], v30 offset:24640
    ds_read_b64_tr_b16 v[194:195], v30 offset:26176
    ds_read_b64_tr_b16 v[196:197], v30 offset:36864
    ds_read_b64_tr_b16 v[198:199], v30 offset:38400
    ds_read_b64_tr_b16 v[200:201], v30 offset:36896
    ds_read_b64_tr_b16 v[202:203], v30 offset:38432
    ds_read_b64_tr_b16 v[204:205], v30 offset:36928
    ds_read_b64_tr_b16 v[206:207], v30 offset:38464
    ds_read_b64_tr_b16 v[208:209], v6 offset:0
    ds_read_b64_tr_b16 v[210:211], v6 offset:1536
    ds_read_b64_tr_b16 v[212:213], v6 offset:32
    ds_read_b64_tr_b16 v[214:215], v6 offset:1568
    ds_read_b64_tr_b16 v[216:217], v6 offset:64
    ds_read_b64_tr_b16 v[218:219], v6 offset:1600
    ds_read_b64_tr_b16 v[220:221], v6 offset:12288
    ds_read_b64_tr_b16 v[222:223], v6 offset:13824
    ds_read_b64_tr_b16 v[224:225], v6 offset:12320
    ds_read_b64_tr_b16 v[226:227], v6 offset:13856
    ds_read_b64_tr_b16 v[228:229], v6 offset:12352
    ds_read_b64_tr_b16 v[230:231], v6 offset:13888
    ds_read_b64_tr_b16 v[232:233], v6 offset:24576
    ds_read_b64_tr_b16 v[234:235], v6 offset:26112
    ds_read_b64_tr_b16 v[236:237], v6 offset:24608
    ds_read_b64_tr_b16 v[238:239], v6 offset:26144
    ds_read_b64_tr_b16 v[240:241], v6 offset:24640
    ds_read_b64_tr_b16 v[242:243], v6 offset:26176
    ds_read_b64_tr_b16 v[244:245], v31 offset:0
    ds_read_b64_tr_b16 v[246:247], v31 offset:1536
    ds_read_b64_tr_b16 v[248:249], v31 offset:32
    ds_read_b64_tr_b16 v[250:251], v31 offset:1568
    ds_read_b64_tr_b16 v[252:253], v31 offset:64
    ds_read_b64_tr_b16 v[254:255], v31 offset:1600
    ds_read_b64_tr_b16 v[128:129], v31 offset:12288
    ds_read_b64_tr_b16 v[130:131], v31 offset:13824
    ds_read_b64_tr_b16 v[132:133], v31 offset:12320
    ds_read_b64_tr_b16 v[134:135], v31 offset:13856
    ds_read_b64_tr_b16 v[136:137], v31 offset:12352
    ds_read_b64_tr_b16 v[138:139], v31 offset:13888
    ds_read_b64_tr_b16 v[140:141], v31 offset:24576
    ds_read_b64_tr_b16 v[142:143], v31 offset:26112
    ds_read_b64_tr_b16 v[144:145], v31 offset:24608
    ds_read_b64_tr_b16 v[146:147], v31 offset:26144
    ds_read_b64_tr_b16 v[148:149], v31 offset:24640
    ds_read_b64_tr_b16 v[150:151], v31 offset:26176
    s_waitcnt lgkmcnt(15)
    v_mfma_f32_16x16x32_bf16 v[80:83], v[32:35], v[160:163], 0
    v_mfma_f32_16x16x32_bf16 v[84:87], v[32:35], v[164:167], 0
    v_mfma_f32_16x16x32_bf16 v[88:91], v[32:35], v[168:171], 0
    s_waitcnt lgkmcnt(15)
    v_mfma_f32_16x16x32_bf16 v[80:83], v[36:39], v[172:175], v[80:83]
    v_mfma_f32_16x16x32_bf16 v[84:87], v[36:39], v[176:179], v[84:87]
    v_mfma_f32_16x16x32_bf16 v[88:91], v[36:39], v[180:183], v[88:91]
    s_waitcnt lgkmcnt(15)
    v_mfma_f32_16x16x32_bf16 v[80:83], v[40:43], v[184:187], v[80:83]
    v_mfma_f32_16x16x32_bf16 v[84:87], v[40:43], v[188:191], v[84:87]
    v_mfma_f32_16x16x32_bf16 v[88:91], v[40:43], v[192:195], v[88:91]
    s_waitcnt lgkmcnt(15)
    v_mfma_f32_16x16x32_bf16 v[80:83], v[44:47], v[196:199], v[80:83]
    v_mfma_f32_16x16x32_bf16 v[84:87], v[44:47], v[200:203], v[84:87]
    v_mfma_f32_16x16x32_bf16 v[88:91], v[44:47], v[204:207], v[88:91]
    s_waitcnt lgkmcnt(15)
    v_mfma_f32_16x16x32_bf16 v[80:83], v[48:51], v[208:211], v[80:83]
    v_mfma_f32_16x16x32_bf16 v[84:87], v[48:51], v[212:215], v[84:87]
    v_mfma_f32_16x16x32_bf16 v[88:91], v[48:51], v[216:219], v[88:91]
    s_waitcnt lgkmcnt(15)
    v_mfma_f32_16x16x32_bf16 v[80:83], v[52:55], v[220:223], v[80:83]
    v_mfma_f32_16x16x32_bf16 v[84:87], v[52:55], v[224:227], v[84:87]
    v_mfma_f32_16x16x32_bf16 v[88:91], v[52:55], v[228:231], v[88:91]
    s_waitcnt lgkmcnt(15)
    v_mfma_f32_16x16x32_bf16 v[80:83], v[56:59], v[232:235], v[80:83]
    v_mfma_f32_16x16x32_bf16 v[84:87], v[56:59], v[236:239], v[84:87]
    v_mfma_f32_16x16x32_bf16 v[88:91], v[56:59], v[240:243], v[88:91]
    s_waitcnt lgkmcnt(12)
    v_mfma_f32_16x16x32_bf16 v[80:83], v[60:63], v[244:247], v[80:83]
    v_mfma_f32_16x16x32_bf16 v[84:87], v[60:63], v[248:251], v[84:87]
    v_mfma_f32_16x16x32_bf16 v[88:91], v[60:63], v[252:255], v[88:91]
    s_waitcnt lgkmcnt(6)
    v_mfma_f32_16x16x32_bf16 v[80:83], v[64:67], v[128:131], v[80:83]
    v_mfma_f32_16x16x32_bf16 v[84:87], v[64:67], v[132:135], v[84:87]
    v_mfma_f32_16x16x32_bf16 v[88:91], v[64:67], v[136:139], v[88:91]
    s_waitcnt lgkmcnt(0)
    v_mfma_f32_16x16x32_bf16 v[80:83], v[68:71], v[140:143], v[80:83]
    v_mfma_f32_16x16x32_bf16 v[84:87], v[68:71], v[144:147], v[84:87]
    v_mfma_f32_16x16x32_bf16 v[88:91], v[68:71], v[148:151], v[88:91]
    s_mov_b64 exec, 0xffff
    s_nop 4
    ds_write_b32 v7, v80 offset:57344
    ds_write_b32 v7, v81 offset:58112
    ds_write_b32 v7, v82 offset:58880
    ds_write_b32 v7, v83 offset:59648
    ds_write_b32 v7, v84 offset:57408
    ds_write_b32 v7, v85 offset:58176
    ds_write_b32 v7, v86 offset:58944
    ds_write_b32 v7, v87 offset:59712
    ds_write_b32 v7, v88 offset:57472
    ds_write_b32 v7, v89 offset:58240
    ds_write_b32 v7, v90 offset:59008
    ds_write_b32 v7, v91 offset:59776
    s_mov_b64 exec, -1
    s_lshl_b32 s76, s72, 2
    s_add_u32 s76, s76, s33
    s_lshl_b32 s76, s76, 12
    s_lshl_b32 s77, s3, 10
    s_add_u32 s76, s76, s77
    s_mul_i32 s78, s3, 768
    v_mul_u32_u24 v5, 12, v0
    v_add_u32 v5, s78, v5
    s_waitcnt lgkmcnt(0)
    s_mov_b64 exec, 1
    ds_add_u32 v1, v2 offset:63492
    s_mov_b64 exec, -1
    s_mov_b32 s81, 8000000
L_lw_7:
    ds_read_b32 v26, v1 offset:63492
    s_waitcnt lgkmcnt(0)
    v_readfirstlane_b32 s79, v26
    s_nop 0
    s_cmp_ge_u32 s79, 4
    s_cbranch_scc1 L_lwd_8
    s_sleep 1
    s_sub_u32 s81, s81, 1
    s_cmp_lg_u32 s81, 0
    s_cbranch_scc1 L_lw_7
L_lwd_8:
    ds_read_b32 v80, v5 offset:57344
    ds_read_b32 v81, v5 offset:57348
    ds_read_b32 v82, v5 offset:57352
    s_waitcnt vmcnt(0)
    s_mov_b32 s81, 2000000
L_gf_p:
    v_readfirstlane_b32 s79, v14
    v_readfirstlane_b32 s80, v15
    s_cmp_eq_u32 s79, 0
    s_cselect_b32 s80, 0, s80
    s_cmp_lg_u32 s80, 0
    s_cbranch_scc1 L_gfd_p
    s_sleep 8
    buffer_load_dwordx2 v[14:15], v1, s[48:51], 0 offen sc1
    s_waitcnt vmcnt(0)
    s_sub_u32 s81, s81, 1
    s_cmp_lg_u32 s81, 0
    s_cbranch_scc1 L_gf_p
L_gfd_p:
    v_mov_b32 v83, v14
    s_waitcnt lgkmcnt(0)
    buffer_store_dwordx4 v[80:83], v4, s[28:31], s76 offen sc1
    s_branch L_q_gather
L_q_consumer:
    s_waitcnt lgkmcnt(0)
    s_mov_b32 s28, s26
    s_mov_b32 s29, s27
    s_mov_b32 s30, 16777216
    s_mov_b32 s31, 0x20000
    s_mov_b32 s48, s24
    s_mov_b32 s49, s25
    s_mov_b32 s50, 256
    s_mov_b32 s51, 0x20000
    s_mov_b32 s40, s4
    s_mov_b32 s41, s5
    s_mov_b32 s42, 5120
    s_mov_b32 s43, 0x20000
    s_mov_b32 s44, s10
    s_mov_b32 s45, s11
    s_mov_b32 s46, 7864320
    s_mov_b32 s47, 0x20000
    s_lshl_b32 s77, s2, 2
    s_add_u32 s77, s77, s3
    s_cmp_lg_u32 s77, 4
    s_cbranch_scc1 L_notag
    s_memrealtime s[78:79]
    s_waitcnt lgkmcnt(0)
    s_or_b32 s78, s78, 1
    s_or_b32 s79, s79, 0x80000000
    v_mov_b32 v80, s78
    v_mov_b32 v81, s79
    v_mov_b32 v82, 0
    v_mov_b32 v83, 0
    s_mov_b64 exec, 1
    buffer_atomic_cmpswap_x2 v[80:83], v1, s[48:51], 0 offen
    s_mov_b64 exec, -1
L_notag:
    s_barrier
    s_mov_b64 exec, 1
    ds_add_u32 v1, v2 offset:63492
    s_mov_b64 exec, -1
    buffer_load_dwordx2 v[14:15], v1, s[48:51], 0 offen sc1
    s_waitcnt vmcnt(0)
    s_mov_b32 s81, 2000000
L_gf_c:
    v_readfirstlane_b32 s79, v14
    v_readfirstlane_b32 s80, v15
    s_cmp_eq_u32 s79, 0
    s_cselect_b32 s80, 0, s80
    s_cmp_lg_u32 s80, 0
    s_cbranch_scc1 L_gfd_c
    s_sleep 8
    buffer_load_dwordx2 v[14:15], v1, s[48:51], 0 offen sc1
    s_waitcnt vmcnt(0)
    s_sub_u32 s81, s81, 1
    s_cmp_lg_u32 s81, 0
    s_cbranch_scc1 L_gf_c
L_gfd_c:
L_q_gather:
    s_mov_b32 s52, s12
    s_mov_b32 s53, s13
    s_mov_b32 s54, 7864320
    s_mov_b32 s55, 0x20000
    s_mov_b32 s56, s16
    s_mov_b32 s57, s17
    s_mov_b32 s58, 1966080
    s_mov_b32 s59, 0x20000
    s_mov_b32 s60, s18
    s_mov_b32 s61, s19
    s_mov_b32 s62, 1966080
    s_mov_b32 s63, 0x20000
    s_mov_b32 s64, s20
    s_mov_b32 s65, s21
    s_mov_b32 s66, 1966080
    s_mov_b32 s67, 0x20000
    s_mov_b32 s68, s22
    s_mov_b32 s69, s23
    s_mov_b32 s70, 5120
    s_mov_b32 s71, 0x20000
    s_mov_b64 exec, 1
    ds_write_b64 v1, v[14:15] offset:63512
    s_mov_b64 exec, -1
    s_lshl_b32 s76, s82, 14
    s_lshl_b32 s77, s3, 10
    s_add_u32 s76, s76, s77
    s_add_u32 s77, s76, 4096
    s_add_u32 s78, s76, 8192
    s_add_u32 s79, s76, 12288
    s_mul_i32 s80, s3, 384
    v_mul_u32_u24 v5, 6, v0
    v_add_u32 v5, s80, v5
    v_lshlrev_b32 v6, 12, v0
    s_mov_b32 s81, 2000000
    s_mov_b64 exec, 3
L_qlight:
    buffer_load_dword v26, v6, s[28:31], s76 offen offset:1020 sc1
    s_waitcnt vmcnt(0)
    v_cmp_ne_u32 vcc, v26, v14
    s_cbranch_vccz L_qlightd
    s_sleep 8
    s_sub_u32 s81, s81, 1
    s_cmp_lg_u32 s81, 0
    s_cbranch_scc1 L_qlight
L_qlightd:
    s_mov_b64 exec, -1
    s_mov_b32 s81, 2000000
    buffer_load_dwordx4 v[128:131], v4, s[28:31], s76 offen sc1
    buffer_load_dwordx4 v[132:135], v4, s[28:31], s77 offen sc1
L_poll_9:
    s_waitcnt vmcnt(0)
    v_cmp_ne_u32 s[4:5], v131, v14
    v_cmp_ne_u32 s[6:7], v135, v14
    s_nop 0
    s_or_b64 s[38:39], s[4:5], s[6:7]
    s_cbranch_scc0 L_pdone_10
    s_sleep 8
    s_mov_b64 exec, s[4:5]
    buffer_load_dwordx4 v[128:131], v4, s[28:31], s76 offen sc1
    s_mov_b64 exec, s[6:7]
    buffer_load_dwordx4 v[132:135], v4, s[28:31], s77 offen sc1
    s_mov_b64 exec, -1
    s_sub_u32 s81, s81, 1
    s_cmp_lg_u32 s81, 0
    s_cbranch_scc1 L_poll_9
    s_waitcnt vmcnt(0)
L_pdone_10:
    v_add_f32 v128, v128, v132
    v_add_f32 v129, v129, v133
    v_add_f32 v130, v130, v134
    v_cvt_pk_bf16_f32 v132, v128, v129
    v_cvt_pk_bf16_f32 v133, v130, v130
    ds_write_b16 v5, v132 offset:54272
    ds_write_b16_d16_hi v5, v132 offset:54274
    ds_write_b16 v5, v133 offset:54276
    s_waitcnt lgkmcnt(0)
    s_mov_b64 exec, 1
    ds_add_u32 v1, v2 offset:63496
    s_mov_b64 exec, -1
    s_setprio 0
    v_and_b32 v26, 15, v0
    v_lshlrev_b32 v13, 5, v26
    v_and_b32 v26, 16, v0
    v_add_u32 v13, v13, v26
    v_cmp_lt_u32 s[34:35], 15, v0
    s_mul_i32 s83, s3, 12288
    s_lshl_b32 s100, s72, 1
    s_add_u32 s100, s100, s73
    s_sub_u32 s100, s100, 6
    s_cmp_gt_u32 s73, 5
    s_cbranch_scc1 L_role_red
    s_mov_b32 s100, s72
    s_mov_b32 s101, s73
    s_cmp_eq_u32 s73, 5
    s_cbranch_scc1 L_role_ffn
    s_mul_i32 s32, s100, 10240
    s_lshl_b32 s77, s101, 11
    s_add_u32 s32, s32, s77
    s_lshl_b32 s77, s3, 9
    s_mov_b32 s44, 0x07060503
    s_mov_b32 s45, 0x07060502
    s_mov_b32 s46, 0x07060501
    s_add_u32 s32, s32, s77
    s_add_u32 s32, s32, 4194304
    v_lshrrev_b32 v5, 4, v0
    v_mul_u32_u24 v5, 1280, v5
    v_and_b32 v26, 15, v0
    v_lshl_add_u32 v5, v26, 4, v5
    s_mul_i32 s76, s100, 245760
    s_lshl_b32 s77, s101, 8
    s_add_u32 s76, s76, s77
    s_mul_i32 s77, s3, 61440
    s_add_u32 s76, s76, s77
    s_mov_b32 s81, 8000000
L_lw_11:
    ds_read_b32 v26, v1 offset:63500
    s_waitcnt lgkmcnt(0)
    v_readfirstlane_b32 s79, v26
    s_nop 0
    s_cmp_ge_u32 s79, 4
    s_cbranch_scc1 L_lwd_12
    s_sleep 16
    s_sub_u32 s81, s81, 1
    s_cmp_lg_u32 s81, 0
    s_cbranch_scc1 L_lw_11
L_lwd_12:
    s_add_u32 m0, s83, 0
    s_nop 0
    buffer_load_dwordx4 v5, s[52:55], s76 offen nt lds
    s_add_u32 s76, s76, 5120
    s_add_u32 m0, s83, 1024
    s_nop 0
    buffer_load_dwordx4 v5, s[52:55], s76 offen nt lds
    s_add_u32 s76, s76, 5120
    s_add_u32 m0, s83, 2048
    s_nop 0
    buffer_load_dwordx4 v5, s[52:55], s76 offen nt lds
    s_add_u32 s76, s76, 5120
    s_add_u32 m0, s83, 3072
    s_nop 0
    buffer_load_dwordx4 v5, s[52:55], s76 offen nt lds
    s_add_u32 s76, s76, 5120
    s_add_u32 m0, s83, 4096
    s_nop 0
    buffer_load_dwordx4 v5, s[52:55], s76 offen nt lds
    s_add_u32 s76, s76, 5120
    s_add_u32 m0, s83, 5120
    s_nop 0
    buffer_load_dwordx4 v5, s[52:55], s76 offen nt lds
    s_add_u32 s76, s76, 5120
    s_add_u32 m0, s83, 6144
    s_nop 0
    buffer_load_dwordx4 v5, s[52:55], s76 offen nt lds
    s_add_u32 s76, s76, 5120
    s_add_u32 m0, s83, 7168
    s_nop 0
    buffer_load_dwordx4 v5, s[52:55], s76 offen nt lds
    s_add_u32 s76, s76, 5120
    s_add_u32 m0, s83, 8192
    s_nop 0
    buffer_load_dwordx4 v5, s[52:55], s76 offen nt lds
    s_add_u32 s76, s76, 5120
    s_add_u32 m0, s83, 9216
    s_nop 0
    buffer_load_dwordx4 v5, s[52:55], s76 offen nt lds
    s_add_u32 s76, s76, 5120
    s_add_u32 m0, s83, 10240
    s_nop 0
    buffer_load_dwordx4 v5, s[52:55], s76 offen nt lds
    s_add_u32 s76, s76, 5120
    s_add_u32 m0, s83, 11264
    s_nop 0
    buffer_load_dwordx4 v5, s[52:55], s76 offen nt lds
    s_add_u32 s76, s76, 5120
    s_lshl_b32 s77, s3, 6
    v_lshrrev_b32 v26, 4, v0
    v_lshlrev_b32 v26, 3, v26
    v_bfe_u32 v27, v0, 2, 2
    v_add_u32 v26, v26, v27
    v_mul_u32_u24 v6, 256, v26
    v_and_b32 v27, 3, v0
    v_lshl_add_u32 v6, v27, 3, v6
    v_add_u32 v6, s77, v6
    s_waitcnt vmcnt(0)
    s_mov_b64 exec, 1
    ds_add_u32 v1, v2 offset:63504
    s_mov_b64 exec, -1
    s_mov_b32 s81, 8000000
L_lw_13:
    ds_read_b32 v26, v1 offset:63504
    s_waitcnt lgkmcnt(0)
    v_readfirstlane_b32 s79, v26
    s_nop 0
    s_cmp_ge_u32 s79, 4
    s_cbranch_scc1 L_lwd_14
    s_sleep 4
    s_sub_u32 s81, s81, 1
    s_cmp_lg_u32 s81, 0
    s_cbranch_scc1 L_lw_13
L_lwd_14:
    ds_read_b64_tr_b16 v[160:161], v6 offset:0
    ds_read_b64_tr_b16 v[162:163], v6 offset:1024
    ds_read_b64_tr_b16 v[164:165], v6 offset:8192
    ds_read_b64_tr_b16 v[166:167], v6 offset:9216
    ds_read_b64_tr_b16 v[168:169], v6 offset:16384
    ds_read_b64_tr_b16 v[170:171], v6 offset:17408
    ds_read_b64_tr_b16 v[172:173], v6 offset:24576
    ds_read_b64_tr_b16 v[174:175], v6 offset:25600
    ds_read_b64_tr_b16 v[176:177], v6 offset:32768
    ds_read_b64_tr_b16 v[178:179], v6 offset:33792
    ds_read_b64_tr_b16 v[180:181], v6 offset:40960
    ds_read_b64_tr_b16 v[182:183], v6 offset:41984
    ds_read_b64_tr_b16 v[184:185], v6 offset:32
    ds_read_b64_tr_b16 v[186:187], v6 offset:1056
    ds_read_b64_tr_b16 v[188:189], v6 offset:8224
    ds_read_b64_tr_b16 v[190:191], v6 offset:9248
    ds_read_b64_tr_b16 v[192:193], v6 offset:16416
    ds_read_b64_tr_b16 v[194:195], v6 offset:17440
    ds_read_b64_tr_b16 v[196:197], v6 offset:24608
    ds_read_b64_tr_b16 v[198:199], v6 offset:25632
    ds_read_b64_tr_b16 v[200:201], v6 offset:32800
    ds_read_b64_tr_b16 v[202:203], v6 offset:33824
    ds_read_b64_tr_b16 v[204:205], v6 offset:40992
    ds_read_b64_tr_b16 v[206:207], v6 offset:42016
    v_and_b32 v26, 3, v0
    v_lshrrev_b32 v27, 4, v0
    v_mul_u32_u24 v122, 384, v26
    v_lshl_add_u32 v122, v27, 4, v122
    v_lshrrev_b32 v26, 3, v0
    v_mul_u32_u24 v26, 3, v26
    v_and_b32 v27, 7, v0
    v_lshlrev_b32 v27, 4, v27
    s_mul_i32 s76, s3, 384
    v_add_u32 v27, s76, v27
    v_add_u32 v28, 0, v26
    v_lshrrev_b32 v29, 3, v28
    v_lshlrev_b32 v29, 7, v29
    v_and_b32 v28, 7, v28
    v_lshlrev_b32 v28, 1, v28
    v_add3_u32 v124, v27, v28, v29
    v_add_u32 v28, 1, v26
    v_lshrrev_b32 v29, 3, v28
    v_lshlrev_b32 v29, 7, v29
    v_and_b32 v28, 7, v28
    v_lshlrev_b32 v28, 1, v28
    v_add3_u32 v125, v27, v28, v29
    v_add_u32 v28, 2, v26
    v_lshrrev_b32 v29, 3, v28
    v_lshlrev_b32 v29, 7, v29
    v_and_b32 v28, 7, v28
    v_lshlrev_b32 v28, 1, v28
    v_add3_u32 v126, v27, v28, v29
    s_lshl_b32 s76, s3, 5
    s_add_u32 s76, s76, s100
    s_lshl_b32 s76, s76, 14
    s_add_u32 s76, s76, 2097152
    s_add_u32 s77, s76, 4096
    s_add_u32 s78, s76, 8192
    s_add_u32 s79, s76, 12288
    v_and_b32 v26, 1, v0
    v_cmp_ne_u32 s[36:37], 0, v26
    v_mov_b32 v36, v14
    v_and_b32 v37, 7, v0
    v_lshlrev_b32 v37, 11, v37
    s_getpc_b64 s[20:21]
L_pc_15:
    s_add_u32 s20, s20, L_tail_wo-L_pc_15
    s_addc_u32 s21, s21, 0
    v_lshlrev_b32 v31, 7, v0
    v_min_u32 v31, (L_role_red-L_tail_wo-4)&~3, v31
    global_load_dword v31, v31, s[20:21]
    s_waitcnt lgkmcnt(0)
    s_barrier
L_tail_wo:
    s_mov_b32 s81, 2000000
    buffer_load_dwordx4 v[128:131], v4, s[28:31], s76 offen offset:0 sc1
    buffer_load_dwordx4 v[132:135], v4, s[28:31], s76 offen offset:2048 sc1
    buffer_load_dwordx4 v[136:139], v4, s[28:31], s77 offen offset:0 sc1
    buffer_load_dwordx4 v[140:143], v4, s[28:31], s77 offen offset:2048 sc1
    buffer_load_dwordx4 v[144:147], v4, s[28:31], s78 offen offset:0 sc1
    buffer_load_dwordx4 v[148:151], v4, s[28:31], s78 offen offset:2048 sc1
    buffer_load_dwordx4 v[152:155], v4, s[28:31], s79 offen offset:0 sc1
    buffer_load_dwordx4 v[156:159], v4, s[28:31], s79 offen offset:2048 sc1
    buffer_load_dwordx4 v[32:35], v37, s[28:31], s76 offen offset:1024 sc1
L_poll_16:
    s_waitcnt vmcnt(0)
    v_cmp_ne_u32 s[4:5], v131, v36
    v_cmp_ne_u32 s[6:7], v135, v36
    v_cmp_ne_u32 s[8:9], v139, v36
    v_cmp_ne_u32 s[10:11], v143, v36
    v_cmp_ne_u32 s[12:13], v147, v36
    v_cmp_ne_u32 s[14:15], v151, v36
    v_cmp_ne_u32 s[16:17], v155, v36
    v_cmp_ne_u32 s[18:19], v159, v36
    v_cmp_ne_u64 s[20:21], v[34:35], v[14:15]
    s_or_b64 s[38:39], s[4:5], s[6:7]
    s_or_b64 s[38:39], s[38:39], s[8:9]
    s_or_b64 s[38:39], s[38:39], s[10:11]
    s_or_b64 s[38:39], s[38:39], s[12:13]
    s_or_b64 s[38:39], s[38:39], s[14:15]
    s_or_b64 s[38:39], s[38:39], s[16:17]
    s_or_b64 s[38:39], s[38:39], s[18:19]
    s_or_b64 s[38:39], s[38:39], s[20:21]
    s_cbranch_scc0 L_pdone_17
    s_sleep 1
    s_mov_b64 exec, s[4:5]
    buffer_load_dwordx4 v[128:131], v4, s[28:31], s76 offen offset:0 sc1
    s_mov_b64 exec, s[6:7]
    buffer_load_dwordx4 v[132:135], v4, s[28:31], s76 offen offset:2048 sc1
    s_mov_b64 exec, s[8:9]
    buffer_load_dwordx4 v[136:139], v4, s[28:31], s77 offen offset:0 sc1
    s_mov_b64 exec, s[10:11]
    buffer_load_dwordx4 v[140:143], v4, s[28:31], s77 offen offset:2048 sc1
    s_mov_b64 exec, s[12:13]
    buffer_load_dwordx4 v[144:147], v4, s[28:31], s78 offen offset:0 sc1
    s_mov_b64 exec, s[14:15]
    buffer_load_dwordx4 v[148:151], v4, s[28:31], s78 offen offset:2048 sc1
    s_mov_b64 exec, s[16:17]
    buffer_load_dwordx4 v[152:155], v4, s[28:31], s79 offen offset:0 sc1
    s_mov_b64 exec, s[18:19]
    buffer_load_dwordx4 v[156:159], v4, s[28:31], s79 offen offset:2048 sc1
    s_mov_b64 exec, s[20:21]
    buffer_load_dwordx4 v[32:35], v37, s[28:31], s76 offen offset:1024 sc1
    s_mov_b64 exec, -1
    s_sub_u32 s81, s81, 1
    s_cmp_lg_u32 s81, 0
    s_cbranch_scc1 L_poll_16
    s_waitcnt vmcnt(0)
L_pdone_17:
    v_max_f32_dpp v26, v32, v32 quad_perm:[1,0,3,2] row_mask:0xf bank_mask:0xf
    s_nop 1
    v_max_f32_dpp v26, v26, v26 quad_perm:[2,3,0,1] row_mask:0xf bank_mask:0xf
    s_nop 1
    v_max_f32_dpp v26, v26, v26 row_half_mirror row_mask:0xf bank_mask:0xf
    v_sub_f32 v26, v32, v26
    v_mul_f32 v26, 0x3fb8aa3b, v26
    v_exp_f32 v26, v26
    s_nop 0
    v_mul_f32 v27, v26, v33
    s_nop 1
    v_add_f32_dpp v27, v27, v27 quad_perm:[1,0,3,2] row_mask:0xf bank_mask:0xf
    s_nop 1
    v_add_f32_dpp v27, v27, v27 quad_perm:[2,3,0,1] row_mask:0xf bank_mask:0xf
    s_nop 1
    v_add_f32_dpp v27, v27, v27 row_half_mirror row_mask:0xf bank_mask:0xf
    v_rcp_f32 v27, v27
    s_nop 0
    v_mul_f32 v26, v26, v27
    s_nop 0
    v_readlane_b32 s4, v26, 0
    v_readlane_b32 s5, v26, 1
    v_readlane_b32 s6, v26, 2
    v_readlane_b32 s7, v26, 3
    v_readlane_b32 s8, v26, 4
    v_readlane_b32 s9, v26, 5
    v_readlane_b32 s10, v26, 6
    v_readlane_b32 s11, v26, 7
    v_mul_f32 v28, s4, v128
    v_mul_f32 v29, s4, v129
    v_mul_f32 v30, s4, v130
    v_fmac_f32 v28, s5, v132
    v_fmac_f32 v29, s5, v133
    v_fmac_f32 v30, s5, v134
    v_fmac_f32 v28, s6, v136
    v_fmac_f32 v29, s6, v137
    v_fmac_f32 v30, s6, v138
    v_fmac_f32 v28, s7, v140
    v_fmac_f32 v29, s7, v141
    v_fmac_f32 v30, s7, v142
    v_fmac_f32 v28, s8, v144
    v_fmac_f32 v29, s8, v145
    v_fmac_f32 v30, s8, v146
    v_fmac_f32 v28, s9, v148
    v_fmac_f32 v29, s9, v149
    v_fmac_f32 v30, s9, v150
    v_fmac_f32 v28, s10, v152
    v_fmac_f32 v29, s10, v153
    v_fmac_f32 v30, s10, v154
    v_fmac_f32 v28, s11, v156
    v_fmac_f32 v29, s11, v157
    v_fmac_f32 v30, s11, v158
    v_cvt_pk_bf16_f32 v26, v28, v29
    v_cvt_pk_bf16_f32 v27, v30, v30
    ds_write_b16 v124, v26 offset:55808
    ds_write_b16_d16_hi v125, v26 offset:55808
    ds_write_b16 v126, v27 offset:55808
    s_waitcnt lgkmcnt(0)
    s_barrier
    ds_read_b128 v[32:35], v122 offset:55808
    ds_read_b128 v[36:39], v122 offset:55872
    ds_read_b128 v[40:43], v122 offset:55936
    ds_read_b128 v[44:47], v122 offset:56000
    ds_read_b128 v[48:51], v122 offset:56064
    ds_read_b128 v[52:55], v122 offset:56128
    s_waitcnt lgkmcnt(5)
    v_mfma_f32_16x16x32_bf16 v[80:83], v[32:35], v[160:163], 0
    v_mfma_f32_16x16x32_bf16 v[84:87], v[32:35], v[184:187], 0
    s_waitcnt lgkmcnt(4)
    v_mfma_f32_16x16x32_bf16 v[80:83], v[36:39], v[164:167], v[80:83]
    v_mfma_f32_16x16x32_bf16 v[84:87], v[36:39], v[188:191], v[84:87]
    s_waitcnt lgkmcnt(3)
    v_mfma_f32_16x16x32_bf16 v[80:83], v[40:43], v[168:171], v[80:83]
    v_mfma_f32_16x16x32_bf16 v[84:87], v[40:43], v[192:195], v[84:87]
    s_waitcnt lgkmcnt(2)
    v_mfma_f32_16x16x32_bf16 v[80:83], v[44:47], v[172:175], v[80:83]
    v_mfma_f32_16x16x32_bf16 v[84:87], v[44:47], v[196:199], v[84:87]
    s_waitcnt lgkmcnt(1)
    v_mfma_f32_16x16x32_bf16 v[80:83], v[48:51], v[176:179], v[80:83]
    v_mfma_f32_16x16x32_bf16 v[84:87], v[48:51], v[200:203], v[84:87]
    s_waitcnt lgkmcnt(0)
    v_mfma_f32_16x16x32_bf16 v[80:83], v[52:55], v[180:183], v[80:83]
    v_mfma_f32_16x16x32_bf16 v[84:87], v[52:55], v[204:207], v[84:87]
    s_mov_b32 exec_hi, 0
    v_mov_b32 v91, v14
    s_nop 5
    v_cndmask_b32 v80, v80, v84, s[34:35]
    v_cndmask_b32 v81, v81, v85, s[34:35]
    v_cndmask_b32 v82, v82, v86, s[34:35]
    v_cndmask_b32 v83, v83, v87, s[34:35]
    v_perm_b32 v88, v80, v83, s44
    v_perm_b32 v89, v81, v83, s45
    v_perm_b32 v90, v82, v83, s46
    buffer_store_dwordx4 v[88:91], v4, s[28:31], s32 offen sc1
    s_mov_b32 exec_hi, -1
    s_branch L_h_end
L_role_red:
    s_lshl_b32 s77, s3, 6
    s_add_u32 s33, s100, s77
    s_cmp_ge_u32 s33, 80
    s_cbranch_scc1 L_h_end
    s_lshl_b32 s36, s33, 7
    s_add_u32 s36, s36, 6291456
    s_lshl_b32 s37, s33, 4
    v_and_b32 v28, 7, v0
    v_lshlrev_b32 v29, 1, v28
    buffer_load_ushort v8, v29, s[40:43], s37 offen offset:0
    buffer_load_ushort v9, v29, s[40:43], s37 offen offset:1280
    buffer_load_ushort v10, v29, s[40:43], s37 offen offset:2560
    buffer_load_ushort v11, v29, s[40:43], s37 offen offset:3840
    v_and_b32 v30, 1, v0
    v_cmp_ne_u32 s[34:35], 0, v30
    v_mul_u32_u24 v5, 2558, v30
    v_add_u32 v5, v5, v29
    v_lshlrev_b32 v7, 4, v28
    v_lshrrev_b32 v30, 3, v0
    v_mul_u32_u24 v6, 10240, v30
    v_lshl_add_u32 v6, v28, 4, v6
    s_mov_b32 s44, 0x0c040000
    s_mov_b32 s45, 0x07060000
    s_waitcnt vmcnt(0)
    v_lshlrev_b32 v92, 16, v8
    v_lshlrev_b32 v93, 16, v9
    v_lshlrev_b32 v94, 16, v10
    v_lshlrev_b32 v95, 16, v11
    s_getpc_b64 s[20:21]
L_pc_18:
    s_add_u32 s20, s20, L_tail_red-L_pc_18
    s_addc_u32 s21, s21, 0
    v_lshlrev_b32 v31, 7, v0
    v_min_u32 v31, (L_role_ffn-L_tail_red-4)&~3, v31
    global_load_dword v31, v31, s[20:21]
    s_barrier
L_tail_red:
    s_lshl_b32 s76, s33, 7
    s_add_u32 s76, s76, 4194304
    s_add_u32 s77, s76, 81920
    s_add_u32 s78, s76, 163840
    s_add_u32 s79, s76, 245760
    s_mov_b32 s81, 2000000
    buffer_load_dwordx4 v[128:131], v6, s[28:31], s76 offen sc1
    buffer_load_dwordx4 v[132:135], v6, s[28:31], s77 offen sc1
    buffer_load_dwordx4 v[136:139], v6, s[28:31], s78 offen sc1
    buffer_load_dwordx4 v[140:143], v6, s[28:31], s79 offen sc1
L_poll_19:
    s_waitcnt vmcnt(0)
    v_cmp_ne_u32 s[4:5], v131, v14
    v_cmp_ne_u32 s[6:7], v135, v14
    v_cmp_ne_u32 s[8:9], v139, v14
    v_cmp_ne_u32 s[10:11], v143, v14
    s_or_b64 s[38:39], s[4:5], s[6:7]
    s_or_b64 s[38:39], s[38:39], s[8:9]
    s_or_b64 s[38:39], s[38:39], s[10:11]
    s_cbranch_scc0 L_pdone_20
    s_sleep 1
    s_mov_b64 exec, s[4:5]
    buffer_load_dwordx4 v[128:131], v6, s[28:31], s76 offen sc1
    s_mov_b64 exec, s[6:7]
    buffer_load_dwordx4 v[132:135], v6, s[28:31], s77 offen sc1
    s_mov_b64 exec, s[8:9]
    buffer_load_dwordx4 v[136:139], v6, s[28:31], s78 offen sc1
    s_mov_b64 exec, s[10:11]
    buffer_load_dwordx4 v[140:143], v6, s[28:31], s79 offen sc1
    s_mov_b64 exec, -1
    s_sub_u32 s81, s81, 1
    s_cmp_lg_u32 s81, 0
    s_cbranch_scc1 L_poll_19
    s_waitcnt vmcnt(0)
L_pdone_20:
    v_lshlrev_b32 v26, 24, v128
    v_and_b32 v27, 0xff, v129
    v_lshl_or_b32 v26, v27, 16, v26
    v_and_b32 v27, 0xff, v130
    v_lshl_or_b32 v131, v27, 8, v26
    v_and_b32 v128, 0xffffff00, v128
    v_and_b32 v129, 0xffffff00, v129
    v_and_b32 v130, 0xffffff00, v130
    v_lshlrev_b32 v26, 24, v132
    v_and_b32 v27, 0xff, v133
    v_lshl_or_b32 v26, v27, 16, v26
    v_and_b32 v27, 0xff, v134
    v_lshl_or_b32 v135, v27, 8, v26
    v_and_b32 v132, 0xffffff00, v132
    v_and_b32 v133, 0xffffff00, v133
    v_and_b32 v134, 0xffffff00, v134
    v_lshlrev_b32 v26, 24, v136
    v_and_b32 v27, 0xff, v137
    v_lshl_or_b32 v26, v27, 16, v26
    v_and_b32 v27, 0xff, v138
    v_lshl_or_b32 v139, v27, 8, v26
    v_and_b32 v136, 0xffffff00, v136
    v_and_b32 v137, 0xffffff00, v137
    v_and_b32 v138, 0xffffff00, v138
    v_lshlrev_b32 v26, 24, v140
    v_and_b32 v27, 0xff, v141
    v_lshl_or_b32 v26, v27, 16, v26
    v_and_b32 v27, 0xff, v142
    v_lshl_or_b32 v143, v27, 8, v26
    v_and_b32 v140, 0xffffff00, v140
    v_and_b32 v141, 0xffffff00, v141
    v_and_b32 v142, 0xffffff00, v142
    v_add_f32 v128, v128, v132
    v_add_f32 v136, v136, v140
    v_add_f32 v129, v129, v133
    v_add_f32 v137, v137, v141
    v_add_f32 v130, v130, v134
    v_add_f32 v138, v138, v142
    v_add_f32 v131, v131, v135
    v_add_f32 v139, v139, v143
    v_add_f32 v128, v128, v136
    v_add_f32 v129, v129, v137
    v_add_f32 v130, v130, v138
    v_add_f32 v131, v131, v139
    v_add_f32_dpp v128, v128, v128 row_ror:8 row_mask:0xf bank_mask:0xf
    v_add_f32_dpp v129, v129, v129 row_ror:8 row_mask:0xf bank_mask:0xf
    v_add_f32_dpp v130, v130, v130 row_ror:8 row_mask:0xf bank_mask:0xf
    v_add_f32_dpp v131, v131, v131 row_ror:8 row_mask:0xf bank_mask:0xf
    v_mov_b32 v132, v128
    v_mov_b32 v133, v129
    v_mov_b32 v134, v130
    v_mov_b32 v135, v131
    v_permlane16_swap_b32 v128, v132
    v_permlane16_swap_b32 v129, v133
    v_permlane16_swap_b32 v130, v134
    v_permlane16_swap_b32 v131, v135
    v_add_f32 v128, v128, v132
    v_add_f32 v129, v129, v133
    v_add_f32 v130, v130, v134
    v_add_f32 v131, v131, v135
    v_mov_b32 v132, v128
    v_mov_b32 v133, v129
    v_mov_b32 v134, v130
    v_mov_b32 v135, v131
    v_permlane32_swap_b32 v128, v132
    v_permlane32_swap_b32 v129, v133
    v_permlane32_swap_b32 v130, v134
    v_permlane32_swap_b32 v131, v135
    v_add_f32 v128, v128, v132
    v_add_f32 v129, v129, v133
    v_add_f32 v130, v130, v134
    v_add_f32 v131, v131, v135
    v_cvt_pk_bf16_f32 v132, v128, v129
    v_cvt_pk_bf16_f32 v133, v130, v131
    v_lshlrev_b32 v128, 16, v132
    v_and_b32 v129, 0xffff0000, v132
    v_lshlrev_b32 v130, 16, v133
    v_and_b32 v131, 0xffff0000, v133
    v_add_f32 v128, v128, v92
    v_add_f32 v129, v129, v93
    v_add_f32 v130, v130, v94
    v_add_f32 v131, v131, v95
    v_cvt_pk_bf16_f32 v132, v128, v129
    v_cvt_pk_bf16_f32 v133, v130, v131
    v_lshlrev_b32 v92, 16, v132
    v_and_b32 v93, 0xffff0000, v132
    v_lshlrev_b32 v94, 16, v133
    v_and_b32 v95, 0xffff0000, v133
    v_cndmask_b32 v134, v133, v132, s[34:35]
    v_cndmask_b32 v135, v132, v133, s[34:35]
    s_nop 0
    v_mov_b32_dpp v134, v134 quad_perm:[1,0,3,2] row_mask:0xf bank_mask:0xf
    v_cndmask_b32 v132, v135, v134, s[34:35]
    v_cndmask_b32 v133, v134, v135, s[34:35]
    v_and_b32 v80, 0xffff, v132
    v_lshl_or_b32 v80, v133, 16, v80
    v_and_b32 v133, 0xffff0000, v133
    v_lshrrev_b32 v81, 16, v132
    v_or_b32 v81, v81, v133
    v_mov_b32 v82, v14
    v_mov_b32 v83, v15
    s_mov_b64 exec, 0xff
    buffer_store_dwordx4 v[80:83], v7, s[28:31], s36 offen sc1
    s_mov_b64 exec, -1
    s_lshl_b32 s76, s33, 7
    s_add_u32 s76, s76, 5242880
    s_add_u32 s77, s76, 81920
    s_add_u32 s78, s76, 163840
    s_add_u32 s79, s76, 245760
    s_mov_b32 s81, 2000000
    buffer_load_dwordx4 v[128:131], v6, s[28:31], s76 offen sc1
    buffer_load_dwordx4 v[132:135], v6, s[28:31], s77 offen sc1
    buffer_load_dwordx4 v[136:139], v6, s[28:31], s78 offen sc1
    buffer_load_dwordx4 v[140:143], v6, s[28:31], s79 offen sc1
L_poll_21:
    s_waitcnt vmcnt(0)
    v_cmp_ne_u32 s[4:5], v131, v14
    v_cmp_ne_u32 s[6:7], v135, v14
    v_cmp_ne_u32 s[8:9], v139, v14
    v_cmp_ne_u32 s[10:11], v143, v14
    s_or_b64 s[38:39], s[4:5], s[6:7]
    s_or_b64 s[38:39], s[38:39], s[8:9]
    s_or_b64 s[38:39], s[38:39], s[10:11]
    s_cbranch_scc0 L_pdone_22
    s_sleep 1
    s_mov_b64 exec, s[4:5]
    buffer_load_dwordx4 v[128:131], v6, s[28:31], s76 offen sc1
    s_mov_b64 exec, s[6:7]
    buffer_load_dwordx4 v[132:135], v6, s[28:31], s77 offen sc1
    s_mov_b64 exec, s[8:9]
    buffer_load_dwordx4 v[136:139], v6, s[28:31], s78 offen sc1
    s_mov_b64 exec, s[10:11]
    buffer_load_dwordx4 v[140:143], v6, s[28:31], s79 offen sc1
    s_mov_b64 exec, -1
    s_sub_u32 s81, s81, 1
    s_cmp_lg_u32 s81, 0
    s_cbranch_scc1 L_poll_21
    s_waitcnt vmcnt(0)
L_pdone_22:
    v_lshlrev_b32 v26, 24, v128
    v_and_b32 v27, 0xff, v129
    v_lshl_or_b32 v26, v27, 16, v26
    v_and_b32 v27, 0xff, v130
    v_lshl_or_b32 v131, v27, 8, v26
    v_and_b32 v128, 0xffffff00, v128
    v_and_b32 v129, 0xffffff00, v129
    v_and_b32 v130, 0xffffff00, v130
    v_lshlrev_b32 v26, 24, v132
    v_and_b32 v27, 0xff, v133
    v_lshl_or_b32 v26, v27, 16, v26
    v_and_b32 v27, 0xff, v134
    v_lshl_or_b32 v135, v27, 8, v26
    v_and_b32 v132, 0xffffff00, v132
    v_and_b32 v133, 0xffffff00, v133
    v_and_b32 v134, 0xffffff00, v134
    v_lshlrev_b32 v26, 24, v136
    v_and_b32 v27, 0xff, v137
    v_lshl_or_b32 v26, v27, 16, v26
    v_and_b32 v27, 0xff, v138
    v_lshl_or_b32 v139, v27, 8, v26
    v_and_b32 v136, 0xffffff00, v136
    v_and_b32 v137, 0xffffff00, v137
    v_and_b32 v138, 0xffffff00, v138
    v_lshlrev_b32 v26, 24, v140
    v_and_b32 v27, 0xff, v141
    v_lshl_or_b32 v26, v27, 16, v26
    v_and_b32 v27, 0xff, v142
    v_lshl_or_b32 v143, v27, 8, v26
    v_and_b32 v140, 0xffffff00, v140
    v_and_b32 v141, 0xffffff00, v141
    v_and_b32 v142, 0xffffff00, v142
    v_add_f32 v128, v128, v132
    v_add_f32 v136, v136, v140
    v_add_f32 v129, v129, v133
    v_add_f32 v137, v137, v141
    v_add_f32 v130, v130, v134
    v_add_f32 v138, v138, v142
    v_add_f32 v131, v131, v135
    v_add_f32 v139, v139, v143
    v_add_f32 v128, v128, v136
    v_add_f32 v129, v129, v137
    v_add_f32 v130, v130, v138
    v_add_f32 v131, v131, v139
    v_add_f32_dpp v128, v128, v128 row_ror:8 row_mask:0xf bank_mask:0xf
    v_add_f32_dpp v129, v129, v129 row_ror:8 row_mask:0xf bank_mask:0xf
    v_add_f32_dpp v130, v130, v130 row_ror:8 row_mask:0xf bank_mask:0xf
    v_add_f32_dpp v131, v131, v131 row_ror:8 row_mask:0xf bank_mask:0xf
    v_mov_b32 v132, v128
    v_mov_b32 v133, v129
    v_mov_b32 v134, v130
    v_mov_b32 v135, v131
    v_permlane16_swap_b32 v128, v132
    v_permlane16_swap_b32 v129, v133
    v_permlane16_swap_b32 v130, v134
    v_permlane16_swap_b32 v131, v135
    v_add_f32 v128, v128, v132
    v_add_f32 v129, v129, v133
    v_add_f32 v130, v130, v134
    v_add_f32 v131, v131, v135
    v_mov_b32 v132, v128
    v_mov_b32 v133, v129
    v_mov_b32 v134, v130
    v_mov_b32 v135, v131
    v_permlane32_swap_b32 v128, v132
    v_permlane32_swap_b32 v129, v133
    v_permlane32_swap_b32 v130, v134
    v_permlane32_swap_b32 v131, v135
    v_add_f32 v128, v128, v132
    v_add_f32 v129, v129, v133
    v_add_f32 v130, v130, v134
    v_add_f32 v131, v131, v135
    v_cvt_pk_bf16_f32 v132, v128, v129
    v_cvt_pk_bf16_f32 v133, v130, v131
    v_lshlrev_b32 v128, 16, v132
    v_and_b32 v129, 0xffff0000, v132
    v_lshlrev_b32 v130, 16, v133
    v_and_b32 v131, 0xffff0000, v133
    v_add_f32 v128, v128, v92
    v_add_f32 v129, v129, v93
    v_add_f32 v130, v130, v94
    v_add_f32 v131, v131, v95
    v_cvt_pk_bf16_f32 v132, v128, v129
    v_cvt_pk_bf16_f32 v133, v130, v131
    v_lshlrev_b32 v92, 16, v132
    v_and_b32 v93, 0xffff0000, v132
    v_lshlrev_b32 v94, 16, v133
    v_and_b32 v95, 0xffff0000, v133
    v_cndmask_b32 v134, v133, v132, s[34:35]
    v_cndmask_b32 v135, v132, v133, s[34:35]
    s_nop 0
    v_mov_b32_dpp v134, v134 quad_perm:[1,0,3,2] row_mask:0xf bank_mask:0xf
    v_cndmask_b32 v132, v135, v134, s[34:35]
    v_cndmask_b32 v133, v134, v135, s[34:35]
    v_and_b32 v80, 0xffff, v132
    v_lshl_or_b32 v80, v133, 16, v80
    v_and_b32 v133, 0xffff0000, v133
    v_lshrrev_b32 v81, 16, v132
    v_or_b32 v81, v81, v133
    s_mov_b64 exec, 0xff
    buffer_store_dword v80, v5, s[68:71], s37 offen
    buffer_store_dword v81, v5, s[68:71], s37 offen offset:1280
    s_mov_b64 exec, -1
    s_branch L_h_end
L_role_ffn:
    s_mul_i32 s32, s100, 10240
    s_mul_i32 s77, s3, 2560
    s_mov_b32 s44, 0x07060503
    s_mov_b32 s45, 0x07060502
    s_mov_b32 s46, 0x07060501
    s_add_u32 s32, s32, s77
    s_add_u32 s32, s32, 5242880
    s_add_u32 s33, s32, 4096
    v_mul_u32_u24 v26, 43, v0
    v_lshrrev_b32 v26, 8, v26
    v_mul_u32_u24 v27, 6, v26
    v_sub_u32 v27, v0, v27
    v_mul_u32_u24 v5, 3072, v26
    v_lshl_add_u32 v5, v27, 4, v5
    v_lshrrev_b32 v26, 4, v0
    v_lshlrev_b32 v26, 3, v26
    v_bfe_u32 v27, v0, 2, 2
    v_add_u32 v26, v26, v27
    v_mul_u32_u24 v6, 96, v26
    v_and_b32 v27, 3, v0
    v_lshl_add_u32 v6, v27, 3, v6
    v_add_u32 v6, s83, v6
    s_mov_b32 s81, 8000000
L_lw_23:
    ds_read_b32 v26, v1 offset:63500
    s_waitcnt lgkmcnt(0)
    v_readfirstlane_b32 s79, v26
    s_nop 0
    s_cmp_ge_u32 s79, 4
    s_cbranch_scc1 L_lwd_24
    s_sleep 16
    s_sub_u32 s81, s81, 1
    s_cmp_lg_u32 s81, 0
    s_cbranch_scc1 L_lw_23
L_lwd_24:
    s_mul_i32 s76, s100, 96
    s_mul_i32 s77, s3, 491520
    s_add_u32 s76, s76, s77
    s_mov_b32 exec_hi, 0xffff
    s_add_u32 m0, s83, 0
    s_nop 0
    buffer_load_dwordx4 v5, s[56:59], s76 offen nt lds
    s_add_u32 s76, s76, 24576
    s_add_u32 m0, s83, 768
    s_nop 0
    buffer_load_dwordx4 v5, s[56:59], s76 offen nt lds
    s_add_u32 s76, s76, 24576
    s_add_u32 m0, s83, 1536
    s_nop 0
    buffer_load_dwordx4 v5, s[56:59], s76 offen nt lds
    s_add_u32 s76, s76, 24576
    s_add_u32 m0, s83, 2304
    s_nop 0
    buffer_load_dwordx4 v5, s[56:59], s76 offen nt lds
    s_add_u32 s76, s76, 24576
    s_add_u32 m0, s83, 3072
    s_nop 0
    buffer_load_dwordx4 v5, s[56:59], s76 offen nt lds
    s_add_u32 s76, s76, 24576
    s_add_u32 m0, s83, 3840
    s_nop 0
    buffer_load_dwordx4 v5, s[56:59], s76 offen nt lds
    s_add_u32 s76, s76, 24576
    s_add_u32 m0, s83, 4608
    s_nop 0
    buffer_load_dwordx4 v5, s[56:59], s76 offen nt lds
    s_add_u32 s76, s76, 24576
    s_add_u32 m0, s83, 5376
    s_nop 0
    buffer_load_dwordx4 v5, s[56:59], s76 offen nt lds
    s_add_u32 s76, s76, 24576
    s_add_u32 m0, s83, 6144
    s_nop 0
    buffer_load_dwordx4 v5, s[56:59], s76 offen nt lds
    s_add_u32 s76, s76, 24576
    s_add_u32 m0, s83, 6912
    s_nop 0
    buffer_load_dwordx4 v5, s[56:59], s76 offen nt lds
    s_add_u32 s76, s76, 24576
    s_add_u32 m0, s83, 7680
    s_nop 0
    buffer_load_dwordx4 v5, s[56:59], s76 offen nt lds
    s_add_u32 s76, s76, 24576
    s_add_u32 m0, s83, 8448
    s_nop 0
    buffer_load_dwordx4 v5, s[56:59], s76 offen nt lds
    s_add_u32 s76, s76, 24576
    s_mov_b32 exec_hi, -1
    s_waitcnt vmcnt(0)
    ds_read_b64_tr_b16 v[136:137], v6 offset:0
    ds_read_b64_tr_b16 v[138:139], v6 offset:384
    ds_read_b64_tr_b16 v[140:141], v6 offset:3072
    ds_read_b64_tr_b16 v[142:143], v6 offset:3456
    ds_read_b64_tr_b16 v[144:145], v6 offset:6144
    ds_read_b64_tr_b16 v[146:147], v6 offset:6528
    ds_read_b64_tr_b16 v[156:157], v6 offset:32
    ds_read_b64_tr_b16 v[158:159], v6 offset:416
    ds_read_b64_tr_b16 v[160:161], v6 offset:3104
    ds_read_b64_tr_b16 v[162:163], v6 offset:3488
    ds_read_b64_tr_b16 v[164:165], v6 offset:6176
    ds_read_b64_tr_b16 v[166:167], v6 offset:6560
    ds_read_b64_tr_b16 v[176:177], v6 offset:64
    ds_read_b64_tr_b16 v[178:179], v6 offset:448
    ds_read_b64_tr_b16 v[180:181], v6 offset:3136
    ds_read_b64_tr_b16 v[182:183], v6 offset:3520
    ds_read_b64_tr_b16 v[184:185], v6 offset:6208
    ds_read_b64_tr_b16 v[186:187], v6 offset:6592
    s_waitcnt lgkmcnt(0)
    s_mov_b32 exec_hi, 0xffff
    s_add_u32 m0, s83, 0
    s_nop 0
    buffer_load_dwordx4 v5, s[56:59], s76 offen nt lds
    s_add_u32 s76, s76, 24576
    s_add_u32 m0, s83, 768
    s_nop 0
    buffer_load_dwordx4 v5, s[56:59], s76 offen nt lds
    s_add_u32 s76, s76, 24576
    s_add_u32 m0, s83, 1536
    s_nop 0
    buffer_load_dwordx4 v5, s[56:59], s76 offen nt lds
    s_add_u32 s76, s76, 24576
    s_add_u32 m0, s83, 2304
    s_nop 0
    buffer_load_dwordx4 v5, s[56:59], s76 offen nt lds
    s_add_u32 s76, s76, 24576
    s_add_u32 m0, s83, 3072
    s_nop 0
    buffer_load_dwordx4 v5, s[56:59], s76 offen nt lds
    s_add_u32 s76, s76, 24576
    s_add_u32 m0, s83, 3840
    s_nop 0
    buffer_load_dwordx4 v5, s[56:59], s76 offen nt lds
    s_add_u32 s76, s76, 24576
    s_add_u32 m0, s83, 4608
    s_nop 0
    buffer_load_dwordx4 v5, s[56:59], s76 offen nt lds
    s_add_u32 s76, s76, 24576
    s_add_u32 m0, s83, 5376
    s_nop 0
    buffer_load_dwordx4 v5, s[56:59], s76 offen nt lds
    s_add_u32 s76, s76, 24576
    s_mov_b32 exec_hi, -1
    s_waitcnt vmcnt(0)
    ds_read_b64_tr_b16 v[148:149], v6 offset:0
    ds_read_b64_tr_b16 v[150:151], v6 offset:384
    ds_read_b64_tr_b16 v[152:153], v6 offset:3072
    ds_read_b64_tr_b16 v[154:155], v6 offset:3456
    ds_read_b64_tr_b16 v[168:169], v6 offset:32
    ds_read_b64_tr_b16 v[170:171], v6 offset:416
    ds_read_b64_tr_b16 v[172:173], v6 offset:3104
    ds_read_b64_tr_b16 v[174:175], v6 offset:3488
    ds_read_b64_tr_b16 v[188:189], v6 offset:64
    ds_read_b64_tr_b16 v[190:191], v6 offset:448
    ds_read_b64_tr_b16 v[192:193], v6 offset:3136
    ds_read_b64_tr_b16 v[194:195], v6 offset:3520
    s_waitcnt lgkmcnt(0)
    s_mul_i32 s76, s100, 96
    s_mul_i32 s77, s3, 491520
    s_add_u32 s76, s76, s77
    s_mov_b32 exec_hi, 0xffff
    s_add_u32 m0, s83, 0
    s_nop 0
    buffer_load_dwordx4 v5, s[60:63], s76 offen nt lds
    s_add_u32 s76, s76, 24576
    s_add_u32 m0, s83, 768
    s_nop 0
    buffer_load_dwordx4 v5, s[60:63], s76 offen nt lds
    s_add_u32 s76, s76, 24576
    s_add_u32 m0, s83, 1536
    s_nop 0
    buffer_load_dwordx4 v5, s[60:63], s76 offen nt lds
    s_add_u32 s76, s76, 24576
    s_add_u32 m0, s83, 2304
    s_nop 0
    buffer_load_dwordx4 v5, s[60:63], s76 offen nt lds
    s_add_u32 s76, s76, 24576
    s_add_u32 m0, s83, 3072
    s_nop 0
    buffer_load_dwordx4 v5, s[60:63], s76 offen nt lds
    s_add_u32 s76, s76, 24576
    s_add_u32 m0, s83, 3840
    s_nop 0
    buffer_load_dwordx4 v5, s[60:63], s76 offen nt lds
    s_add_u32 s76, s76, 24576
    s_add_u32 m0, s83, 4608
    s_nop 0
    buffer_load_dwordx4 v5, s[60:63], s76 offen nt lds
    s_add_u32 s76, s76, 24576
    s_add_u32 m0, s83, 5376
    s_nop 0
    buffer_load_dwordx4 v5, s[60:63], s76 offen nt lds
    s_add_u32 s76, s76, 24576
    s_add_u32 m0, s83, 6144
    s_nop 0
    buffer_load_dwordx4 v5, s[60:63], s76 offen nt lds
    s_add_u32 s76, s76, 24576
    s_add_u32 m0, s83, 6912
    s_nop 0
    buffer_load_dwordx4 v5, s[60:63], s76 offen nt lds
    s_add_u32 s76, s76, 24576
    s_add_u32 m0, s83, 7680
    s_nop 0
    buffer_load_dwordx4 v5, s[60:63], s76 offen nt lds
    s_add_u32 s76, s76, 24576
    s_add_u32 m0, s83, 8448
    s_nop 0
    buffer_load_dwordx4 v5, s[60:63], s76 offen nt lds
    s_add_u32 s76, s76, 24576
    s_mov_b32 exec_hi, -1
    s_waitcnt vmcnt(0)
    ds_read_b64_tr_b16 v[196:197], v6 offset:0
    ds_read_b64_tr_b16 v[198:199], v6 offset:384
    ds_read_b64_tr_b16 v[200:201], v6 offset:3072
    ds_read_b64_tr_b16 v[202:203], v6 offset:3456
    ds_read_b64_tr_b16 v[204:205], v6 offset:6144
    ds_read_b64_tr_b16 v[206:207], v6 offset:6528
    ds_read_b64_tr_b16 v[216:217], v6 offset:32
    ds_read_b64_tr_b16 v[218:219], v6 offset:416
    ds_read_b64_tr_b16 v[220:221], v6 offset:3104
    ds_read_b64_tr_b16 v[222:223], v6 offset:3488
    ds_read_b64_tr_b16 v[224:225], v6 offset:6176
    ds_read_b64_tr_b16 v[226:227], v6 offset:6560
    ds_read_b64_tr_b16 v[236:237], v6 offset:64
    ds_read_b64_tr_b16 v[238:239], v6 offset:448
    ds_read_b64_tr_b16 v[240:241], v6 offset:3136
    ds_read_b64_tr_b16 v[242:243], v6 offset:3520
    ds_read_b64_tr_b16 v[244:245], v6 offset:6208
    ds_read_b64_tr_b16 v[246:247], v6 offset:6592
    s_waitcnt lgkmcnt(0)
    s_mov_b32 exec_hi, 0xffff
    s_add_u32 m0, s83, 0
    s_nop 0
    buffer_load_dwordx4 v5, s[60:63], s76 offen nt lds
    s_add_u32 s76, s76, 24576
    s_add_u32 m0, s83, 768
    s_nop 0
    buffer_load_dwordx4 v5, s[60:63], s76 offen nt lds
    s_add_u32 s76, s76, 24576
    s_add_u32 m0, s83, 1536
    s_nop 0
    buffer_load_dwordx4 v5, s[60:63], s76 offen nt lds
    s_add_u32 s76, s76, 24576
    s_add_u32 m0, s83, 2304
    s_nop 0
    buffer_load_dwordx4 v5, s[60:63], s76 offen nt lds
    s_add_u32 s76, s76, 24576
    s_add_u32 m0, s83, 3072
    s_nop 0
    buffer_load_dwordx4 v5, s[60:63], s76 offen nt lds
    s_add_u32 s76, s76, 24576
    s_add_u32 m0, s83, 3840
    s_nop 0
    buffer_load_dwordx4 v5, s[60:63], s76 offen nt lds
    s_add_u32 s76, s76, 24576
    s_add_u32 m0, s83, 4608
    s_nop 0
    buffer_load_dwordx4 v5, s[60:63], s76 offen nt lds
    s_add_u32 s76, s76, 24576
    s_add_u32 m0, s83, 5376
    s_nop 0
    buffer_load_dwordx4 v5, s[60:63], s76 offen nt lds
    s_add_u32 s76, s76, 24576
    s_mov_b32 exec_hi, -1
    s_waitcnt vmcnt(0)
    ds_read_b64_tr_b16 v[208:209], v6 offset:0
    ds_read_b64_tr_b16 v[210:211], v6 offset:384
    ds_read_b64_tr_b16 v[212:213], v6 offset:3072
    ds_read_b64_tr_b16 v[214:215], v6 offset:3456
    ds_read_b64_tr_b16 v[228:229], v6 offset:32
    ds_read_b64_tr_b16 v[230:231], v6 offset:416
    ds_read_b64_tr_b16 v[232:233], v6 offset:3104
    ds_read_b64_tr_b16 v[234:235], v6 offset:3488
    ds_read_b64_tr_b16 v[248:249], v6 offset:64
    ds_read_b64_tr_b16 v[250:251], v6 offset:448
    ds_read_b64_tr_b16 v[252:253], v6 offset:3136
    ds_read_b64_tr_b16 v[254:255], v6 offset:3520
    s_waitcnt lgkmcnt(0)
    s_mul_i32 s22, s100, 61440
    s_mul_i32 s23, s3, 15360
    s_add_u32 s22, s22, s23
    s_add_u32 s23, s23, 63552
    s_mov_b32 s81, 8000000
L_lw_25:
    ds_read_b32 v26, v1 offset:63500
    s_waitcnt lgkmcnt(0)
    v_readfirstlane_b32 s79, v26
    s_nop 0
    s_cmp_ge_u32 s79, 4
    s_cbranch_scc1 L_lwd_26
    s_sleep 16
    s_sub_u32 s81, s81, 1
    s_cmp_lg_u32 s81, 0
    s_cbranch_scc1 L_lw_25
L_lwd_26:
    s_add_u32 m0, s23, 0
    s_nop 0
    buffer_load_dwordx4 v4, s[64:67], s22 offen nt lds
    s_add_u32 s22, s22, 1024
    s_add_u32 m0, s23, 1024
    s_nop 0
    buffer_load_dwordx4 v4, s[64:67], s22 offen nt lds
    s_add_u32 s22, s22, 1024
    s_add_u32 m0, s23, 2048
    s_nop 0
    buffer_load_dwordx4 v4, s[64:67], s22 offen nt lds
    s_add_u32 s22, s22, 1024
    s_add_u32 m0, s23, 3072
    s_nop 0
    buffer_load_dwordx4 v4, s[64:67], s22 offen nt lds
    s_add_u32 s22, s22, 1024
    s_add_u32 m0, s23, 4096
    s_nop 0
    buffer_load_dwordx4 v4, s[64:67], s22 offen nt lds
    s_add_u32 s22, s22, 1024
    s_add_u32 m0, s23, 5120
    s_nop 0
    buffer_load_dwordx4 v4, s[64:67], s22 offen nt lds
    s_add_u32 s22, s22, 1024
    s_add_u32 m0, s23, 6144
    s_nop 0
    buffer_load_dwordx4 v4, s[64:67], s22 offen nt lds
    s_add_u32 s22, s22, 1024
    s_add_u32 m0, s23, 7168
    s_nop 0
    buffer_load_dwordx4 v4, s[64:67], s22 offen nt lds
    s_add_u32 s22, s22, 1024
    s_add_u32 m0, s23, 8192
    s_nop 0
    buffer_load_dwordx4 v4, s[64:67], s22 offen nt lds
    s_add_u32 s22, s22, 1024
    s_add_u32 m0, s23, 9216
    s_nop 0
    buffer_load_dwordx4 v4, s[64:67], s22 offen nt lds
    s_add_u32 s22, s22, 1024
    s_add_u32 m0, s23, 10240
    s_nop 0
    buffer_load_dwordx4 v4, s[64:67], s22 offen nt lds
    s_add_u32 s22, s22, 1024
    s_add_u32 m0, s23, 11264
    s_nop 0
    buffer_load_dwordx4 v4, s[64:67], s22 offen nt lds
    s_add_u32 s22, s22, 1024
    s_add_u32 m0, s23, 12288
    s_nop 0
    buffer_load_dwordx4 v4, s[64:67], s22 offen nt lds
    s_add_u32 s22, s22, 1024
    s_add_u32 m0, s23, 13312
    s_nop 0
    buffer_load_dwordx4 v4, s[64:67], s22 offen nt lds
    s_add_u32 s22, s22, 1024
    s_add_u32 m0, s23, 14336
    s_nop 0
    buffer_load_dwordx4 v4, s[64:67], s22 offen nt lds
    s_add_u32 s22, s22, 1024
    s_mul_i32 s23, s3, 320
    s_add_u32 s23, s23, 63552
    v_lshrrev_b32 v26, 4, v0
    v_lshlrev_b32 v26, 2, v26
    v_bfe_u32 v27, v0, 2, 2
    v_add_u32 v26, v26, v27
    v_mul_u32_u24 v6, 1280, v26
    v_and_b32 v27, 3, v0
    v_lshl_add_u32 v6, v27, 3, v6
    v_add_u32 v6, s23, v6
    s_waitcnt vmcnt(0)
    s_mov_b64 exec, 1
    ds_add_u32 v1, v2 offset:63504
    s_mov_b64 exec, -1
    s_mov_b32 s81, 8000000
L_lw_27:
    ds_read_b32 v26, v1 offset:63504
    s_waitcnt lgkmcnt(0)
    v_readfirstlane_b32 s79, v26
    s_nop 0
    s_cmp_ge_u32 s79, 4
    s_cbranch_scc1 L_lwd_28
    s_sleep 4
    s_sub_u32 s81, s81, 1
    s_cmp_lg_u32 s81, 0
    s_cbranch_scc1 L_lw_27
L_lwd_28:
    ds_read_b64_tr_b16 v[76:77], v6 offset:0
    ds_read_b64_tr_b16 v[78:79], v6 offset:20480
    ds_read_b64_tr_b16 v[80:81], v6 offset:40960
    ds_read_b64_tr_b16 v[82:83], v6 offset:32
    ds_read_b64_tr_b16 v[84:85], v6 offset:20512
    ds_read_b64_tr_b16 v[86:87], v6 offset:40992
    ds_read_b64_tr_b16 v[88:89], v6 offset:64
    ds_read_b64_tr_b16 v[90:91], v6 offset:20544
    ds_read_b64_tr_b16 v[92:93], v6 offset:41024
    ds_read_b64_tr_b16 v[94:95], v6 offset:96
    ds_read_b64_tr_b16 v[96:97], v6 offset:20576
    ds_read_b64_tr_b16 v[98:99], v6 offset:41056
    ds_read_b64_tr_b16 v[100:101], v6 offset:128
    ds_read_b64_tr_b16 v[102:103], v6 offset:20608
    ds_read_b64_tr_b16 v[104:105], v6 offset:41088
    ds_read_b64_tr_b16 v[106:107], v6 offset:160
    ds_read_b64_tr_b16 v[108:109], v6 offset:20640
    ds_read_b64_tr_b16 v[110:111], v6 offset:41120
    ds_read_b64_tr_b16 v[112:113], v6 offset:192
    ds_read_b64_tr_b16 v[114:115], v6 offset:20672
    ds_read_b64_tr_b16 v[116:117], v6 offset:41152
    ds_read_b64_tr_b16 v[118:119], v6 offset:224
    ds_read_b64_tr_b16 v[120:121], v6 offset:20704
    ds_read_b64_tr_b16 v[122:123], v6 offset:41184
    ds_read_b64_tr_b16 v[124:125], v6 offset:256
    ds_read_b64_tr_b16 v[126:127], v6 offset:20736
    ds_read_b64_tr_b16 v[128:129], v6 offset:41216
    ds_read_b64_tr_b16 v[130:131], v6 offset:288
    ds_read_b64_tr_b16 v[132:133], v6 offset:20768
    ds_read_b64_tr_b16 v[134:135], v6 offset:41248
    s_waitcnt lgkmcnt(0)
    s_mul_i32 s75, s3, 1280
    s_lshr_b32 s79, s3, 1
    s_lshl_b32 s79, s79, 4
    s_add_u32 s76, s79, 6291456
    s_add_u32 s77, s76, 4096
    s_add_u32 s78, s76, 8192
    v_add_u32 v5, s75, v3
    v_and_b32 v26, 3, v0
    v_lshrrev_b32 v27, 4, v0
    v_mul_u32_u24 v6, 1280, v26
    v_lshl_add_u32 v6, v27, 4, v6
    s_mul_i32 s79, s3, 320
    v_add_u32 v6, s79, v6
    s_mul_i32 s79, s3, 1536
    v_add_u32 v7, s79, v4
    v_and_b32 v28, 15, v0
    v_lshlrev_b32 v1, 4, v28
    v_lshl_add_u32 v1, v27, 2, v1
    s_lshl_b32 s79, s3, 8
    v_add_u32 v1, s79, v1
    v_mul_u32_u24 v2, 96, v27
    v_lshl_add_u32 v2, v28, 1, v2
    s_lshl_b32 s79, s3, 5
    v_add_u32 v2, s79, v2
    v_mul_u32_u24 v3, 96, v26
    v_lshl_add_u32 v3, v27, 3, v3
    v_lshlrev_b32 v4, 5, v0
    s_bitcmp1_b32 s3, 0
    s_cselect_b64 s[36:37], -1, 0
    s_getpc_b64 s[20:21]
L_pc_29:
    s_add_u32 s20, s20, L_tail_ffn-L_pc_29
    s_addc_u32 s21, s21, 0
    v_lshlrev_b32 v31, 7, v0
    v_min_u32 v31, (L_end-L_tail_ffn-4)&~3, v31
    global_load_dword v31, v31, s[20:21]
    s_barrier
L_tail_ffn:
    s_mov_b32 s81, 2000000
    buffer_load_dwordx4 v[32:35], v4, s[28:31], s76 offen offset:0 sc1
    buffer_load_dwordx4 v[36:39], v4, s[28:31], s76 offen offset:2048 sc1
    buffer_load_dwordx4 v[40:43], v4, s[28:31], s77 offen offset:0 sc1
    buffer_load_dwordx4 v[44:47], v4, s[28:31], s77 offen offset:2048 sc1
    buffer_load_dwordx4 v[48:51], v4, s[28:31], s78 offen offset:0 sc1
L_poll_30:
    s_waitcnt vmcnt(0)
    v_cmp_ne_u64 s[4:5], v[34:35], v[14:15]
    v_cmp_ne_u64 s[6:7], v[38:39], v[14:15]
    v_cmp_ne_u64 s[8:9], v[42:43], v[14:15]
    v_cmp_ne_u64 s[10:11], v[46:47], v[14:15]
    v_cmp_ne_u64 s[12:13], v[50:51], v[14:15]
    s_or_b64 s[38:39], s[4:5], s[6:7]
    s_or_b64 s[38:39], s[38:39], s[8:9]
    s_or_b64 s[38:39], s[38:39], s[10:11]
    s_or_b64 s[38:39], s[38:39], s[12:13]
    s_cbranch_scc0 L_pdone_31
    s_sleep 1
    s_mov_b64 exec, s[4:5]
    buffer_load_dwordx4 v[32:35], v4, s[28:31], s76 offen offset:0 sc1
    s_mov_b64 exec, s[6:7]
    buffer_load_dwordx4 v[36:39], v4, s[28:31], s76 offen offset:2048 sc1
    s_mov_b64 exec, s[8:9]
    buffer_load_dwordx4 v[40:43], v4, s[28:31], s77 offen offset:0 sc1
    s_mov_b64 exec, s[10:11]
    buffer_load_dwordx4 v[44:47], v4, s[28:31], s77 offen offset:2048 sc1
    s_mov_b64 exec, s[12:13]
    buffer_load_dwordx4 v[48:51], v4, s[28:31], s78 offen offset:0 sc1
    s_mov_b64 exec, -1
    s_sub_u32 s81, s81, 1
    s_cmp_lg_u32 s81, 0
    s_cbranch_scc1 L_poll_30
    s_waitcnt vmcnt(0)
L_pdone_31:
    v_cndmask_b32 v8, v32, v33, s[36:37]
    v_cndmask_b32 v9, v36, v37, s[36:37]
    v_cndmask_b32 v10, v40, v41, s[36:37]
    v_cndmask_b32 v11, v44, v45, s[36:37]
    v_cndmask_b32 v12, v48, v49, s[36:37]
    s_mov_b32 s80, 0x44200000
    v_lshlrev_b32 v16, 16, v8
    v_and_b32 v17, 0xffff0000, v8
    v_lshlrev_b32 v18, 16, v9
    v_and_b32 v19, 0xffff0000, v9
    v_lshlrev_b32 v20, 16, v10
    v_and_b32 v21, 0xffff0000, v10
    v_lshlrev_b32 v22, 16, v11
    v_and_b32 v23, 0xffff0000, v11
    v_lshlrev_b32 v24, 16, v12
    v_and_b32 v25, 0xffff0000, v12
    v_add_f32 v26, v16, v17
    v_add_f32 v27, v18, v19
    v_add_f32 v28, v20, v21
    v_add_f32 v29, v22, v23
    v_add_f32 v30, v24, v25
    v_add_f32 v26, v26, v27
    v_add_f32 v28, v28, v29
    v_add_f32 v26, v26, v30
    v_add_f32 v26, v26, v28
    v_readfirstlane_b32 s79, v16
    s_nop 1
    v_subrev_f32 v28, s79, v16
    v_mul_f32 v27, v28, v28
    v_subrev_f32 v29, s79, v17
    v_fmac_f32 v27, v29, v29
    v_subrev_f32 v28, s79, v18
    v_fmac_f32 v27, v28, v28
    v_subrev_f32 v29, s79, v19
    v_fmac_f32 v27, v29, v29
    v_subrev_f32 v28, s79, v20
    v_fmac_f32 v27, v28, v28
    v_subrev_f32 v29, s79, v21
    v_fmac_f32 v27, v29, v29
    v_subrev_f32 v28, s79, v22
    v_fmac_f32 v27, v28, v28
    v_subrev_f32 v29, s79, v23
    v_fmac_f32 v27, v29, v29
    v_subrev_f32 v28, s79, v24
    v_fmac_f32 v27, v28, v28
    v_subrev_f32 v29, s79, v25
    v_fmac_f32 v27, v29, v29
    v_add_f32_dpp v26, v26, v26 quad_perm:[1,0,3,2] row_mask:0xf bank_mask:0xf
    s_nop 0
    v_add_f32_dpp v27, v27, v27 quad_perm:[1,0,3,2] row_mask:0xf bank_mask:0xf
    v_add_f32_dpp v26, v26, v26 quad_perm:[2,3,0,1] row_mask:0xf bank_mask:0xf
    s_nop 0
    v_add_f32_dpp v27, v27, v27 quad_perm:[2,3,0,1] row_mask:0xf bank_mask:0xf
    v_add_f32_dpp v26, v26, v26 row_ror:4 row_mask:0xf bank_mask:0xf
    s_nop 0
    v_add_f32_dpp v27, v27, v27 row_ror:4 row_mask:0xf bank_mask:0xf
    v_add_f32_dpp v26, v26, v26 row_ror:8 row_mask:0xf bank_mask:0xf
    s_nop 0
    v_add_f32_dpp v27, v27, v27 row_ror:8 row_mask:0xf bank_mask:0xf
    v_mov_b32 v28, v26
    v_mov_b32 v29, v27
    s_nop 0
    v_permlane16_swap_b32 v26, v28
    v_permlane16_swap_b32 v27, v29
    v_add_f32 v26, v26, v28
    v_add_f32 v27, v27, v29
    v_mov_b32 v28, v26
    v_mov_b32 v29, v27
    s_nop 0
    v_permlane32_swap_b32 v26, v28
    v_permlane32_swap_b32 v27, v29
    v_add_f32 v26, v26, v28
    v_add_f32 v27, v27, v29
    v_mul_f32 v28, 0x3acccccd, v26
    v_fma_f32 v29, -v28, s80, v26
    v_mul_f32 v29, 0x3acccccd, v29
    v_add_f32 v26, v28, v29
    v_mul_f32 v30, 0x3acccccd, v27
    v_fma_f32 v31, -v30, s80, v27
    v_mul_f32 v31, 0x3acccccd, v31
    v_add_f32 v27, v30, v31
    v_subrev_f32 v28, s79, v26
    v_fma_f32 v27, -v28, v28, v27
    v_max_f32 v27, 0, v27
    v_cvt_pk_bf16_f32 v26, v26, v26
    v_lshlrev_b32 v26, 16, v26
    v_cvt_pk_bf16_f32 v27, v27, v27
    v_lshlrev_b32 v27, 16, v27
    v_add_f32 v27, 0x3727c5ac, v27
    v_cvt_pk_bf16_f32 v27, v27, v27
    v_lshlrev_b32 v27, 16, v27
    v_sqrt_f32 v27, v27
    s_nop 0
    v_cvt_pk_bf16_f32 v27, v27, v27
    v_lshlrev_b32 v27, 16, v27
    v_rcp_f32 v28, v27
    v_sub_f32 v16, v16, v26
    v_sub_f32 v17, v17, v26
    v_cvt_pk_bf16_f32 v17, v16, v17
    v_lshlrev_b32 v16, 16, v17
    v_and_b32 v17, 0xffff0000, v17
    v_mul_f32 v29, v16, v28
    v_mul_f32 v30, v17, v28
    v_fma_f32 v16, -v29, v27, v16
    v_fma_f32 v17, -v30, v27, v17
    v_fmac_f32 v29, v16, v28
    v_fmac_f32 v30, v17, v28
    v_cvt_pk_bf16_f32 v8, v29, v30
    v_sub_f32 v18, v18, v26
    v_sub_f32 v19, v19, v26
    v_cvt_pk_bf16_f32 v19, v18, v19
    v_lshlrev_b32 v18, 16, v19
    v_and_b32 v19, 0xffff0000, v19
    v_mul_f32 v29, v18, v28
    v_mul_f32 v30, v19, v28
    v_fma_f32 v18, -v29, v27, v18
    v_fma_f32 v19, -v30, v27, v19
    v_fmac_f32 v29, v18, v28
    v_fmac_f32 v30, v19, v28
    v_cvt_pk_bf16_f32 v9, v29, v30
    v_sub_f32 v20, v20, v26
    v_sub_f32 v21, v21, v26
    v_cvt_pk_bf16_f32 v21, v20, v21
    v_lshlrev_b32 v20, 16, v21
    v_and_b32 v21, 0xffff0000, v21
    v_mul_f32 v29, v20, v28
    v_mul_f32 v30, v21, v28
    v_fma_f32 v20, -v29, v27, v20
    v_fma_f32 v21, -v30, v27, v21
    v_fmac_f32 v29, v20, v28
    v_fmac_f32 v30, v21, v28
    v_cvt_pk_bf16_f32 v10, v29, v30
    v_sub_f32 v22, v22, v26
    v_sub_f32 v23, v23, v26
    v_cvt_pk_bf16_f32 v23, v22, v23
    v_lshlrev_b32 v22, 16, v23
    v_and_b32 v23, 0xffff0000, v23
    v_mul_f32 v29, v22, v28
    v_mul_f32 v30, v23, v28
    v_fma_f32 v22, -v29, v27, v22
    v_fma_f32 v23, -v30, v27, v23
    v_fmac_f32 v29, v22, v28
    v_fmac_f32 v30, v23, v28
    v_cvt_pk_bf16_f32 v11, v29, v30
    v_sub_f32 v24, v24, v26
    v_sub_f32 v25, v25, v26
    v_cvt_pk_bf16_f32 v25, v24, v25
    v_lshlrev_b32 v24, 16, v25
    v_and_b32 v25, 0xffff0000, v25
    v_mul_f32 v29, v24, v28
    v_mul_f32 v30, v25, v28
    v_fma_f32 v24, -v29, v27, v24
    v_fma_f32 v25, -v30, v27, v25
    v_fmac_f32 v29, v24, v28
    v_fmac_f32 v30, v25, v28
    v_cvt_pk_bf16_f32 v12, v29, v30
    ds_write_b32 v5, v8 offset:49152
    ds_write_b32 v5, v9 offset:49408
    ds_write_b32 v5, v10 offset:49664
    ds_write_b32 v5, v11 offset:49920
    ds_write_b32 v5, v12 offset:50176
    s_waitcnt lgkmcnt(0)
    s_barrier
    ds_read_b128 v[32:35], v6 offset:49152
    ds_read_b128 v[36:39], v6 offset:49216
    ds_read_b128 v[40:43], v6 offset:49280
    ds_read_b128 v[44:47], v6 offset:49344
    ds_read_b128 v[48:51], v6 offset:49408
    s_waitcnt lgkmcnt(4)
    v_mfma_f32_16x16x32_bf16 v[52:55], v[32:35], v[136:139], 0
    v_mfma_f32_16x16x32_bf16 v[56:59], v[32:35], v[156:159], 0
    v_mfma_f32_16x16x32_bf16 v[60:63], v[32:35], v[176:179], 0
    v_mfma_f32_16x16x32_bf16 v[64:67], v[32:35], v[196:199], 0
    v_mfma_f32_16x16x32_bf16 v[68:71], v[32:35], v[216:219], 0
    v_mfma_f32_16x16x32_bf16 v[72:75], v[32:35], v[236:239], 0
    s_waitcnt lgkmcnt(3)
    v_mfma_f32_16x16x32_bf16 v[52:55], v[36:39], v[140:143], v[52:55]
    v_mfma_f32_16x16x32_bf16 v[56:59], v[36:39], v[160:163], v[56:59]
    v_mfma_f32_16x16x32_bf16 v[60:63], v[36:39], v[180:183], v[60:63]
    v_mfma_f32_16x16x32_bf16 v[64:67], v[36:39], v[200:203], v[64:67]
    v_mfma_f32_16x16x32_bf16 v[68:71], v[36:39], v[220:223], v[68:71]
    v_mfma_f32_16x16x32_bf16 v[72:75], v[36:39], v[240:243], v[72:75]
    s_waitcnt lgkmcnt(2)
    v_mfma_f32_16x16x32_bf16 v[52:55], v[40:43], v[144:147], v[52:55]
    v_mfma_f32_16x16x32_bf16 v[56:59], v[40:43], v[164:167], v[56:59]
    v_mfma_f32_16x16x32_bf16 v[60:63], v[40:43], v[184:187], v[60:63]
    v_mfma_f32_16x16x32_bf16 v[64:67], v[40:43], v[204:207], v[64:67]
    v_mfma_f32_16x16x32_bf16 v[68:71], v[40:43], v[224:227], v[68:71]
    v_mfma_f32_16x16x32_bf16 v[72:75], v[40:43], v[244:247], v[72:75]
    s_waitcnt lgkmcnt(1)
    v_mfma_f32_16x16x32_bf16 v[52:55], v[44:47], v[148:151], v[52:55]
    v_mfma_f32_16x16x32_bf16 v[56:59], v[44:47], v[168:171], v[56:59]
    v_mfma_f32_16x16x32_bf16 v[60:63], v[44:47], v[188:191], v[60:63]
    v_mfma_f32_16x16x32_bf16 v[64:67], v[44:47], v[208:211], v[64:67]
    v_mfma_f32_16x16x32_bf16 v[68:71], v[44:47], v[228:231], v[68:71]
    v_mfma_f32_16x16x32_bf16 v[72:75], v[44:47], v[248:251], v[72:75]
    s_waitcnt lgkmcnt(0)
    v_mfma_f32_16x16x32_bf16 v[52:55], v[48:51], v[152:155], v[52:55]
    v_mfma_f32_16x16x32_bf16 v[56:59], v[48:51], v[172:175], v[56:59]
    v_mfma_f32_16x16x32_bf16 v[60:63], v[48:51], v[192:195], v[60:63]
    v_mfma_f32_16x16x32_bf16 v[64:67], v[48:51], v[212:215], v[64:67]
    v_mfma_f32_16x16x32_bf16 v[68:71], v[48:51], v[232:235], v[68:71]
    v_mfma_f32_16x16x32_bf16 v[72:75], v[48:51], v[252:255], v[72:75]
    s_mov_b64 exec, 0xffff
    s_nop 1
    ds_write_b128 v7, v[52:55] offset:57344
    ds_write_b128 v7, v[56:59] offset:57600
    ds_write_b128 v7, v[60:63] offset:57856
    ds_write_b128 v7, v[64:67] offset:58112
    ds_write_b128 v7, v[68:71] offset:58368
    ds_write_b128 v7, v[72:75] offset:58624
    s_mov_b64 exec, -1
    s_waitcnt lgkmcnt(0)
    s_barrier
    s_cmp_eq_u32 s3, 3
    s_cbranch_scc1 L_noact
    ds_read_b32 v16, v1 offset:57344
    ds_read_b32 v20, v1 offset:58112
    ds_read_b32 v17, v1 offset:58880
    ds_read_b32 v21, v1 offset:59648
    ds_read_b32 v18, v1 offset:60416
    ds_read_b32 v22, v1 offset:61184
    ds_read_b32 v19, v1 offset:61952
    ds_read_b32 v23, v1 offset:62720
    s_waitcnt lgkmcnt(0)
    v_add_f32 v16, v16, v17
    v_add_f32 v18, v18, v19
    v_add_f32 v16, v16, v18
    v_add_f32 v20, v20, v21
    v_add_f32 v22, v22, v23
    v_add_f32 v20, v20, v22
    v_cvt_pk_bf16_f32 v16, v16, v16
    v_lshlrev_b32 v16, 16, v16
    v_cvt_pk_bf16_f32 v20, v20, v20
    v_lshlrev_b32 v20, 16, v20
    v_mul_f32 v17, 0xbfb8aa3b, v16
    v_exp_f32 v17, v17
    s_nop 0
    v_add_f32 v17, 1.0, v17
    v_rcp_f32 v17, v17
    s_nop 0
    v_mul_f32 v16, v16, v17
    v_cvt_pk_bf16_f32 v16, v16, v16
    v_lshlrev_b32 v16, 16, v16
    v_mul_f32 v16, v16, v20
    v_cvt_pk_bf16_f32 v16, v16, v16
    ds_write_b16 v2, v16 offset:55808
    s_waitcnt lgkmcnt(0)
L_noact:
    v_and_b32 v26, 16, v0
    v_cmp_ne_u32 s[34:35], 0, v26
    v_cmp_lt_u32 s[38:39], 31, v0
    v_lshlrev_b32 v13, 4, v0
    v_mov_b32 v55, v14
    v_mov_b32 v59, v14
    v_mov_b32 v63, v14
    s_barrier
    ds_read_b64 v[32:33], v3 offset:55808
    ds_read_b64 v[34:35], v3 offset:55840
    ds_read_b64 v[36:37], v3 offset:55872
    s_waitcnt lgkmcnt(0)
    v_mfma_f32_16x16x16_bf16 v[136:139], v[32:33], v[76:77], 0
    v_mfma_f32_16x16x16_bf16 v[136:139], v[34:35], v[78:79], v[136:139]
    v_mfma_f32_16x16x16_bf16 v[136:139], v[36:37], v[80:81], v[136:139]
    v_mfma_f32_16x16x16_bf16 v[140:143], v[32:33], v[82:83], 0
    v_mfma_f32_16x16x16_bf16 v[140:143], v[34:35], v[84:85], v[140:143]
    v_mfma_f32_16x16x16_bf16 v[140:143], v[36:37], v[86:87], v[140:143]
    v_mfma_f32_16x16x16_bf16 v[144:147], v[32:33], v[88:89], 0
    v_mfma_f32_16x16x16_bf16 v[144:147], v[34:35], v[90:91], v[144:147]
    v_mfma_f32_16x16x16_bf16 v[144:147], v[36:37], v[92:93], v[144:147]
    v_mfma_f32_16x16x16_bf16 v[148:151], v[32:33], v[94:95], 0
    v_mfma_f32_16x16x16_bf16 v[148:151], v[34:35], v[96:97], v[148:151]
    v_mfma_f32_16x16x16_bf16 v[148:151], v[36:37], v[98:99], v[148:151]
    v_mfma_f32_16x16x16_bf16 v[152:155], v[32:33], v[100:101], 0
    v_mfma_f32_16x16x16_bf16 v[152:155], v[34:35], v[102:103], v[152:155]
    v_mfma_f32_16x16x16_bf16 v[152:155], v[36:37], v[104:105], v[152:155]
    v_mfma_f32_16x16x16_bf16 v[156:159], v[32:33], v[106:107], 0
    v_mfma_f32_16x16x16_bf16 v[156:159], v[34:35], v[108:109], v[156:159]
    v_mfma_f32_16x16x16_bf16 v[156:159], v[36:37], v[110:111], v[156:159]
    v_cndmask_b32 v136, v136, v140, s[34:35]
    s_nop 0
    v_cndmask_b32 v144, v144, v148, s[34:35]
    v_cndmask_b32 v136, v136, v144, s[38:39]
    v_cndmask_b32 v137, v137, v141, s[34:35]
    v_cndmask_b32 v145, v145, v149, s[34:35]
    v_cndmask_b32 v137, v137, v145, s[38:39]
    v_cndmask_b32 v138, v138, v142, s[34:35]
    v_cndmask_b32 v146, v146, v150, s[34:35]
    v_cndmask_b32 v138, v138, v146, s[38:39]
    v_cndmask_b32 v139, v139, v143, s[34:35]
    v_cndmask_b32 v147, v147, v151, s[34:35]
    v_cndmask_b32 v139, v139, v147, s[38:39]
    v_perm_b32 v52, v136, v139, s44
    v_perm_b32 v53, v137, v139, s45
    v_perm_b32 v54, v138, v139, s46
    buffer_store_dwordx4 v[52:55], v13, s[28:31], s32 offen offset:0 sc1
    v_mfma_f32_16x16x16_bf16 v[160:163], v[32:33], v[112:113], 0
    v_mfma_f32_16x16x16_bf16 v[160:163], v[34:35], v[114:115], v[160:163]
    v_mfma_f32_16x16x16_bf16 v[160:163], v[36:37], v[116:117], v[160:163]
    v_mfma_f32_16x16x16_bf16 v[164:167], v[32:33], v[118:119], 0
    v_mfma_f32_16x16x16_bf16 v[164:167], v[34:35], v[120:121], v[164:167]
    v_mfma_f32_16x16x16_bf16 v[164:167], v[36:37], v[122:123], v[164:167]
    v_mfma_f32_16x16x16_bf16 v[168:171], v[32:33], v[124:125], 0
    v_mfma_f32_16x16x16_bf16 v[168:171], v[34:35], v[126:127], v[168:171]
    v_mfma_f32_16x16x16_bf16 v[168:171], v[36:37], v[128:129], v[168:171]
    v_mfma_f32_16x16x16_bf16 v[172:175], v[32:33], v[130:131], 0
    v_mfma_f32_16x16x16_bf16 v[172:175], v[34:35], v[132:133], v[172:175]
    v_mfma_f32_16x16x16_bf16 v[172:175], v[36:37], v[134:135], v[172:175]
    v_cndmask_b32 v152, v152, v156, s[34:35]
    s_nop 0
    v_cndmask_b32 v160, v160, v164, s[34:35]
    v_cndmask_b32 v152, v152, v160, s[38:39]
    v_cndmask_b32 v153, v153, v157, s[34:35]
    v_cndmask_b32 v161, v161, v165, s[34:35]
    v_cndmask_b32 v153, v153, v161, s[38:39]
    v_cndmask_b32 v154, v154, v158, s[34:35]
    v_cndmask_b32 v162, v162, v166, s[34:35]
    v_cndmask_b32 v154, v154, v162, s[38:39]
    v_cndmask_b32 v155, v155, v159, s[34:35]
    v_cndmask_b32 v163, v163, v167, s[34:35]
    v_cndmask_b32 v155, v155, v163, s[38:39]
    v_perm_b32 v56, v152, v155, s44
    v_perm_b32 v57, v153, v155, s45
    v_perm_b32 v58, v154, v155, s46
    buffer_store_dwordx4 v[56:59], v13, s[28:31], s32 offen offset:1024 sc1
    v_cndmask_b32 v168, v168, v172, s[34:35]
    v_cndmask_b32 v169, v169, v173, s[34:35]
    v_cndmask_b32 v170, v170, v174, s[34:35]
    v_cndmask_b32 v171, v171, v175, s[34:35]
    v_perm_b32 v60, v168, v171, s44
    v_perm_b32 v61, v169, v171, s45
    v_perm_b32 v62, v170, v171, s46
    s_mov_b32 exec_hi, 0
    buffer_store_dwordx4 v[60:63], v13, s[28:31], s32 offen offset:2048 sc1
    s_mov_b32 exec_hi, -1
L_h_end:
L_end:
    s_endpgm
.section .rodata,"a"
.p2align 6
.amdhsa_kernel sequential_preLN__gqa_block_cached__swiglu_ffn__decode_kernel
  .amdhsa_next_free_vgpr 256
  .amdhsa_next_free_sgpr 102
  .amdhsa_accum_offset 256
  .amdhsa_group_segment_fixed_size 0
  .amdhsa_float_denorm_mode_32 3
  .amdhsa_kernarg_size 96
  .amdhsa_user_sgpr_count 2
  .amdhsa_user_sgpr_kernarg_segment_ptr 1
  .amdhsa_system_sgpr_workgroup_id_x 1
.end_amdhsa_kernel
```
